```python
import torch

def _softmax(x, axis=-1):
    return torch.softmax(x, dim=axis)
def _gelu(x):
    return torch.nn.functional.gelu(x, approximate="tanh")
def _silu(x):
    return torch.nn.functional.silu(x)
def _sigmoid(x):
    return torch.sigmoid(x)
def _layernorm(x, axis=-1, eps=1e-5):
    m = x.mean(dim=axis, keepdim=True)
    v = x.var(dim=axis, keepdim=True, unbiased=False)
    return (x - m) / torch.sqrt(v + eps)
def _scatter_add(tgt, idx, src, axis=0):
    return tgt.clone().index_add_(axis, idx, src)
def _segment_sum(src, seg, n):
    out = torch.zeros((n,) + src.shape[1:], dtype=src.dtype)
    return out.index_add_(0, seg, src)
def _pad(x, pw):
    flat = tuple(v for pair in reversed(pw) for v in pair)
    return torch.nn.functional.pad(x, flat)

kernel_name = 'sequential_preLN__ssm_conv_s4d__glu_gated_swiglu__prompt'

def setup_inputs():

    _w = (lambda a: (lambda t: t.to(torch.bfloat16) if t.is_floating_point() else t)(torch.as_tensor(a)))
    def _A_setup():
        Bsz, L, D, N = 1, 2048, 640, 128
        return {
            "u": _w((lambda *s: torch.randn(*s, dtype=torch.bfloat16) * 0.05)(Bsz, L, D)),
            "log_A_real": _w((lambda *s: torch.randn(*s, dtype=torch.bfloat16) * 6.4)(D, N) * 0.5),
            "A_imag": _w((lambda *s: torch.randn(*s, dtype=torch.bfloat16) * 0.05)(D, N) * 3.14),
            "C_real": _w((lambda *s: torch.randn(*s, dtype=torch.bfloat16) * 0.05)(D, N) / N ** 0.5),
            "C_imag": _w((lambda *s: torch.randn(*s, dtype=torch.bfloat16) * 0.05)(D, N) / N ** 0.5),
            "log_dt": _w((lambda *s: torch.randn(*s, dtype=torch.bfloat16) * 0.05)(D) * 0.5 - 4.0),
            "D_skip": _w((lambda *s: torch.randn(*s, dtype=torch.bfloat16) * 0.05)(D)),
        }
    _A_in = _A_setup()

    def _B_setup():
        B, S, D, F = 1, 2048, 640, 1728
        return {
            "x": _w((lambda *s: torch.randn(*s, dtype=torch.bfloat16) * 0.05)(B, S, D)),
            "w1": _w((lambda *s: torch.randn(*s, dtype=torch.bfloat16) * 0.4)(D, F) * (2.0 / D) ** 0.5),
            "w3": _w((lambda *s: torch.randn(*s, dtype=torch.bfloat16) * 0.4)(D, F) * (2.0 / D) ** 0.5),
            "w2": _w((lambda *s: torch.randn(*s, dtype=torch.bfloat16) * 0.4)(F, D) * (2.0 / F) ** 0.5),
        }
    _B_in = _B_setup()

    return {
        "A_u": _A_in["u"],
        "A_log_A_real": _A_in["log_A_real"],
        "A_A_imag": _A_in["A_imag"],
        "A_C_real": _A_in["C_real"],
        "A_C_imag": _A_in["C_imag"],
        "A_log_dt": _A_in["log_dt"],
        "A_D_skip": _A_in["D_skip"],
        "B_x": _B_in["x"],
        "B_w1": _B_in["w1"],
        "B_w3": _B_in["w3"],
        "B_w2": _B_in["w2"],
    }

def reference(A_u, A_log_A_real, A_A_imag, A_C_real, A_C_imag, A_log_dt, A_D_skip, B_x, B_w1, B_w3, B_w2):
    def _A_ref(u, log_A_real, A_imag, C_real, C_imag, log_dt, D_skip):
        L = u.shape[1]
        dt = torch.exp(log_dt)
        A = -torch.exp(log_A_real) + 1j * A_imag
        C = (C_real + 1j * C_imag) * dt[:, None]
        pos = (lambda x, dt: x.to(dt))(torch.arange(L), log_dt.dtype)
        P = torch.exp((A * dt[:, None])[:, :, None] * pos[None, None, :])
        K = 2.0 * torch.einsum("dn,dnl->dl", C, P).real
        L2 = 2 * L
        u_t = (lambda x, *d: x.permute(*d))(u, 0, 2, 1)
        Kf = (lambda x, *a, **k: torch.fft.rfft(x.float(), *a, **k))(K, L2)
        Uf = (lambda x, *a, **k: torch.fft.rfft(x.float(), *a, **k))(u_t, L2)
        y = (lambda x, *a, **k: torch.fft.irfft(x, *a, **k).to(torch.bfloat16))(Uf * Kf[None, :, :], L2)[:, :, :L]
        y = (lambda x, *d: x.permute(*d))(y, 0, 2, 1)
        return y + u * D_skip[None, None, :]

    def _B_ref(x, w1, w3, w2):
        gate = torch.einsum("bsd,df->bsf", x, w1)
        up = torch.einsum("bsd,df->bsf", x, w3)
        h = _silu(gate) * up
        out = torch.einsum("bsf,fd->bsd", h, w2)
        return out

    x = A_u
    h = x + _A_ref(_layernorm(x, axis=-1), A_log_A_real, A_A_imag, A_C_real, A_C_imag, A_log_dt, A_D_skip)
    h2 = h + _B_ref(_layernorm(h, axis=-1), B_w1, B_w3, B_w2)
    return h2
```

```asm
; @launch grid=(256,1,1) block=(512,1,1) lds=163840
.amdgcn_target "amdgcn-amd-amdhsa--gfx950"
.text
.globl sequential_preLN__ssm_conv_s4d__glu_gated_swiglu__prompt_kernel
.p2align 8
.type sequential_preLN__ssm_conv_s4d__glu_gated_swiglu__prompt_kernel,@function
sequential_preLN__ssm_conv_s4d__glu_gated_swiglu__prompt_kernel:
    s_cmp_ge_u32 s2, 256
    s_cbranch_scc1 L_end1
    s_load_dwordx8 s[4:11], s[0:1], 0
    s_load_dwordx2 s[76:77], s[0:1], 48
    s_load_dwordx2 s[100:101], s[0:1], 104
    s_load_dwordx4 s[72:75], s[0:1], 32
    s_load_dwordx8 s[80:87], s[0:1], 64
    v_lshrrev_b32 v3, 6, v0
    v_and_b32 v2, 63, v0
    v_readfirstlane_b32 s64, v3
    v_mul_u32_u24_e64 v3, 20, v2
    s_lshr_b32 s3, s2, 2
    s_lshl_b32 s3, s3, 5
    s_and_b32 s70, s2, 3
    s_add_u32 s3, s3, s70
    s_lshl_b32 s70, s64, 2
    s_add_u32 s3, s3, s70
    s_mul_i32 s3, s3, 1280
    s_waitcnt lgkmcnt(0)
    s_mov_b32 s12, s4
    s_mov_b32 s13, s5
    s_mov_b32 s14, 2621440
    s_mov_b32 s15, 0x00020000
    buffer_load_dwordx4 v[16:19], v3, s[12:15], s3 offen
    buffer_load_dword v20, v3, s[12:15], s3 offen offset:16
    s_add_u32 s70, s100, 32768000
    s_addc_u32 s71, s101, 0
    s_load_dword s56, s[70:71], 0
    s_bfe_u32 s70, s2, 0x40003
    s_lshr_b32 s71, s2, 7
    s_add_u32 s65, s71, 2
    s_mul_i32 s66, s70, s65
    s_sub_u32 s78, 7, s71
    s_mul_i32 s79, s71, 14
    s_lshl_b32 s71, s71, 2
    s_add_u32 s66, s66, s79
    s_cmp_ge_u32 s70, s78
    s_cselect_b32 s79, 18, 0
    s_cselect_b32 s3, s71, 0
    s_sub_u32 s79, s79, s3
    s_add_u32 s66, s66, s79
    s_lshl_b32 s78, s78, 1
    s_lshl_b32 s71, s71, 2
    s_lshr_b32 s3, s71, 3
    s_sub_u32 s71, s71, s3
    s_sub_u32 s71, 18, s71
    s_cmp_ge_u32 s70, s78
    s_cselect_b32 s79, s71, 0
    s_add_u32 s66, s66, s79
    s_and_b32 s70, s2, 1
    s_lshl_b32 s70, s70, 4
    s_add_u32 s66, s66, s70
    s_cmp_ge_u32 s66, 80
    s_cselect_b32 s70, 80, 0
    s_sub_u32 s66, s66, s70
    s_and_b32 s70, s2, 7
    s_mul_i32 s70, s70, 80
    s_add_u32 s66, s66, s70
    s_mov_b32 s16, s76
    s_mov_b32 s17, s77
    s_mov_b32 s18, 1280
    s_mov_b32 s19, 0x00020000
    s_mov_b32 s36, s74
    s_mov_b32 s37, s75
    s_mov_b32 s38, 1280
    s_mov_b32 s39, 0x00020000
    s_lshl_b32 s79, s66, 1
    s_and_b32 s79, s79, 0xfffffffc
    s_bitcmp1_b32 s64, 1
    s_cselect_b32 s96, s82, s80
    s_cselect_b32 s97, s83, s81
    s_cselect_b32 s24, s10, s6
    s_cselect_b32 s25, s11, s7
    s_cselect_b32 s26, s72, s8
    s_cselect_b32 s27, s73, s9
    s_buffer_load_dwordx2 s[8:9], s[36:39], s79
    s_buffer_load_dwordx2 s[10:11], s[16:19], s79
    s_mov_b32 s99, 0x00020000
    v_lshlrev_b32 v5, 4, v2
    v_lshrrev_b32_e64 v31, 3, v2
    s_cmp_ge_u32 s64, 4
    s_cbranch_scc1 L_hp6
    v_bfe_u32 v35, v2, 1, 2
    v_and_b32_e64 v36, 1, v2
    v_lshl_add_u32 v35, v31, 5, v35
    v_lshl_add_u32 v35, v36, 4, v35
    v_mul_u32_u24 v87, 1280, v35
    s_mul_i32 s75, s64, 655360
    s_add_u32 s79, s75, s79
    s_mov_b32 s60, s100
    s_mov_b32 s61, s101
    s_mov_b32 s62, 16384
    s_mov_b32 s63, 0x00020000
    s_mov_b32 s52, s86
    s_mov_b32 s53, s87
    s_mov_b32 s54, 2621440
    s_mov_b32 s55, 0x00020000
    s_lshr_b32 s70, s2, 5
    s_bfe_u32 s71, s2, 0x20001
    s_mul_i32 s71, s71, 7
    s_add_u32 s71, s71, s70
    s_cmp_ge_u32 s70, 7
    s_cselect_b32 s57, 27, s71
    s_lshl_b32 s67, s57, 7
    s_and_b32 s70, s64, 1
    s_mul_i32 s71, s70, 27648
    s_add_u32 s67, s67, s71
    s_cmp_lt_u32 s57, 27
    s_cselect_b32 s58, 1, 0
    s_lshl_b32 s70, s70, 7
    s_add_u32 s70, s70, 147456
    v_lshl_add_u32 v80, v2, 1, s70
    s_and_b32 s76, s64, 3
    v_lshrrev_b32 v29, 3, v2
    v_mul_u32_u24 v11, 3456, v29
    v_bfe_u32 v30, v2, 1, 2
    v_bfe_u32 v29, v2, 4, 1
    v_xor_b32 v30, v30, v29
    s_and_b32 s70, s64, 2
    v_xor_b32_e64 v30, s70, v30
    v_lshl_add_u32 v11, v30, 5, v11
    v_and_b32_e64 v30, 1, v2
    v_lshl_add_u32 v11, v30, 4, v11
    s_mul_i32 s98, s58, 2211840
    s_lshl_b32 s84, s64, 10
    s_barrier
    s_add_u32 m0, s84, 80896
    s_add_u32 s78, s67, 0
    buffer_load_dwordx4 v11, s[96:99], s78 offen lds
    s_add_u32 m0, s84, 84992
    s_add_u32 s78, s67, 55296
    buffer_load_dwordx4 v11, s[96:99], s78 offen lds
    buffer_load_dwordx2 v[96:97], v87, s[12:15], s79 offen
    s_add_u32 s79, s79, 5120
    buffer_load_dwordx2 v[98:99], v87, s[12:15], s79 offen
    s_add_u32 s79, s79, 5120
    buffer_load_dwordx2 v[100:101], v87, s[12:15], s79 offen
    s_add_u32 s79, s79, 5120
    buffer_load_dwordx2 v[102:103], v87, s[12:15], s79 offen
    s_add_u32 s79, s79, 312320
    v_mov_b32 v36, 0
    v_mov_b32 v37, 0
    v_mov_b32 v38, 0
    v_mov_b32 v39, 0
    v_lshlrev_b32 v32, 4, v0
    v_add_u32 v32, 126976, v32
    v_lshlrev_b32_e64 v81, 5, v2
    ds_write_b128 v32, v[36:39]
    s_waitcnt vmcnt(6) lgkmcnt(0)
    s_add_u32 s56, s56, 1
    v_lshlrev_b32_e64 v28, 16, v16
    v_and_b32 v29, 0xffff0000, v16
    v_lshlrev_b32_e64 v30, 16, v17
    v_and_b32 v31, 0xffff0000, v17
    v_lshlrev_b32_e64 v32, 16, v18
    v_and_b32 v33, 0xffff0000, v18
    v_lshlrev_b32_e64 v34, 16, v19
    v_and_b32 v35, 0xffff0000, v19
    v_lshlrev_b32_e64 v36, 16, v20
    v_and_b32 v37, 0xffff0000, v20
    v_pk_add_f32 v[16:17], v[28:29], v[30:31]
    v_pk_mul_f32 v[18:19], v[28:29], v[28:29]
    v_pk_add_f32 v[20:21], v[32:33], v[34:35]
    v_pk_fma_f32 v[18:19], v[30:31], v[30:31], v[18:19]
    v_pk_add_f32 v[16:17], v[16:17], v[36:37]
    v_pk_fma_f32 v[18:19], v[32:33], v[32:33], v[18:19]
    v_pk_add_f32 v[16:17], v[16:17], v[20:21]
    v_pk_fma_f32 v[18:19], v[34:35], v[34:35], v[18:19]
    v_pk_fma_f32 v[18:19], v[36:37], v[36:37], v[18:19]
    v_add_f32 v16, v16, v17
    v_add_f32 v18, v18, v19
    s_and_b32 s70, s66, 1
    s_lshl_b32 s70, s70, 4
    v_add_f32_dpp v16, v16, v16 row_shr:1 row_mask:0xf bank_mask:0xf bound_ctrl:0
    v_add_f32_dpp v18, v18, v18 row_shr:1 row_mask:0xf bank_mask:0xf bound_ctrl:0
    s_lshr_b64 s[8:9], s[8:9], s70
    v_add_f32_dpp v16, v16, v16 row_shr:2 row_mask:0xf bank_mask:0xf bound_ctrl:0
    v_add_f32_dpp v18, v18, v18 row_shr:2 row_mask:0xf bank_mask:0xf bound_ctrl:0
    s_lshr_b64 s[10:11], s[10:11], s70
    v_add_f32_dpp v16, v16, v16 row_shr:4 row_mask:0xf bank_mask:0xf bound_ctrl:0
    v_add_f32_dpp v18, v18, v18 row_shr:4 row_mask:0xf bank_mask:0xf bound_ctrl:0
    s_lshl_b32 s70, s76, 4
    v_add_f32_dpp v16, v16, v16 row_shr:8 row_mask:0xf bank_mask:0xf bound_ctrl:0
    v_add_f32_dpp v18, v18, v18 row_shr:8 row_mask:0xf bank_mask:0xf bound_ctrl:0
    s_lshr_b64 s[10:11], s[10:11], s70
    v_add_f32_dpp v16, v16, v16 row_bcast:15 row_mask:0xa bank_mask:0xf
    v_add_f32_dpp v18, v18, v18 row_bcast:15 row_mask:0xa bank_mask:0xf
    s_lshl_b32 s3, s10, 16
    v_add_f32_dpp v16, v16, v16 row_bcast:31 row_mask:0xc bank_mask:0xf
    v_add_f32_dpp v18, v18, v18 row_bcast:31 row_mask:0xc bank_mask:0xf
    s_lshl_b32 s70, s8, 16
    s_and_b32 s71, s8, 0xffff0000
    s_lshl_b32 s74, s9, 16
    v_mov_b32 v68, s70
    v_mov_b32 v69, s71
    v_mov_b32 v70, s74
    v_readlane_b32 s72, v16, 63
    v_readlane_b32 s73, v18, 63
    v_mov_b32 v20, 986500301
    s_nop 1
    v_mul_f32 v16, s72, v20
    v_mul_f32_e64 v18, s73, v20
    v_fma_f32 v18, -v16, v16, v18
    v_max_f32_e64 v18, 0, v18
    v_cvt_pk_bf16_f32 v18, v18, v18
    v_and_b32 v18, 0xffff0000, v18
    v_add_f32 v18, 0x3727c5ac, v18
    v_cvt_pk_bf16_f32 v18, v18, v18
    v_and_b32 v18, 0xffff0000, v18
    v_sqrt_f32_e64 v18, v18
    v_cvt_pk_bf16_f32 v16, v16, v16
    v_and_b32 v16, 0xffff0000, v16
    v_cvt_pk_bf16_f32 v18, v18, v18
    v_and_b32 v18, 0xffff0000, v18
    s_lshl_b32 s72, s64, 3
    s_lshl_b32 s73, s2, 6
    v_lshrrev_b32 v16, 16, v16
    v_mov_b32 v17, s56
    v_or_b32_e64 v16, v16, v18
    s_add_u32 s72, s72, 151552
    v_mov_b32 v20, s72
    s_mov_b64 exec, 1
    ds_write_b64 v20, v[16:17]
    s_mov_b64 exec, -1
    s_waitcnt lgkmcnt(0)
    s_barrier
    ds_read_u16_d16_hi v62, v80 offset:0
    ds_read_u16_d16_hi v63, v80 offset:256
    ds_read_u16_d16_hi v64, v80 offset:512
    ds_read_u16_d16_hi v65, v80 offset:768
    ds_read_u16_d16_hi v66, v80 offset:1024
    ds_read_u16_d16_hi v67, v80 offset:1280
    s_mov_b32 s84, 1069066811
    s_and_b32 s85, s64, 1
    s_lshl_b32 s85, s85, 8
    s_waitcnt lgkmcnt(0)
    v_mul_f32 v16, s84, v62
    v_mul_f32 v17, s84, v63
    v_mul_f32 v18, s84, v64
    v_mul_f32 v68, s84, v68
    v_mul_f32 v69, s84, v69
    v_mul_f32 v70, s84, v70
    v_exp_f32 v16, v16
    v_exp_f32 v17, v17
    v_exp_f32 v18, v18
    v_exp_f32 v68, v68
    v_exp_f32 v69, v69
    v_exp_f32 v70, v70
    v_cvt_pk_bf16_f32 v16, v16, v16
    v_cvt_pk_bf16_f32 v17, v17, v17
    v_cvt_pk_bf16_f32 v18, v18, v18
    v_cvt_pk_bf16_f32 v68, v68, v68
    v_cvt_pk_bf16_f32 v69, v69, v69
    v_cvt_pk_bf16_f32 v70, v70, v70
    v_and_b32 v16, 0xffff0000, v16
    v_and_b32 v17, 0xffff0000, v17
    v_and_b32 v18, 0xffff0000, v18
    v_and_b32 v68, 0xffff0000, v68
    v_and_b32 v69, 0xffff0000, v69
    v_and_b32 v70, 0xffff0000, v70
    v_mul_f32 v16, v16, v68
    v_mul_f32 v17, v17, v69
    v_mul_f32 v18, v18, v70
    v_mul_f32 v19, v65, v68
    v_mul_f32 v20, v66, v69
    v_mul_f32 v21, v67, v70
    v_mul_f32 v16, 3216550459, v16
    v_mul_f32 v17, 3216550459, v17
    v_mul_f32 v18, 3216550459, v18
    v_mul_f32 v19, 0.15915494, v19
    v_mul_f32 v20, 0.15915494, v20
    v_mul_f32_e64 v21, 0.15915494, v21
    s_bfe_u32 s86, s64, 0x10001
    s_mul_i32 s87, s86, 8448
    s_add_u32 s87, s85, s87
    s_mov_b32 m0, s87
    s_mul_i32 s86, s86, 1124073472
    s_lshl_b32 s84, s64, 10
    s_lshl_b32 s74, s64, 12
    v_mul_f32 v50, 0x41000000, v16
    v_mul_f32 v52, 0x41000000, v17
    v_mul_f32 v54, 0x41000000, v18
    v_mul_f32 v51, 0x41000000, v19
    v_mul_f32 v53, 0x41000000, v20
    v_mul_f32 v55, 0x41000000, v21
    v_exp_f32 v50, v50
    v_exp_f32 v52, v52
    v_exp_f32 v54, v54
    v_fract_f32 v51, v51
    v_fract_f32 v53, v53
    v_fract_f32 v55, v55
    v_cos_f32 v32, v51
    v_cos_f32 v34, v53
    v_cos_f32 v36, v55
    v_sin_f32 v33, v51
    v_sin_f32 v35, v53
    v_sin_f32 v37, v55
    v_pk_mul_f32 v[32:33], v[32:33], v[50:51] op_sel:[0,0] op_sel_hi:[1,0]
    v_pk_mul_f32 v[34:35], v[34:35], v[52:53] op_sel:[0,0] op_sel_hi:[1,0]
    v_pk_mul_f32 v[36:37], v[36:37], v[54:55] op_sel:[0,0] op_sel_hi:[1,0]
    v_mul_f32 v50, s86, v16
    v_mul_f32 v52, s86, v17
    v_mul_f32 v54, s86, v18
    v_mul_f32 v51, s86, v19
    v_mul_f32 v53, s86, v20
    v_mul_f32 v55, s86, v21
    v_exp_f32 v50, v50
    v_exp_f32 v52, v52
    v_exp_f32 v54, v54
    v_fract_f32 v51, v51
    v_fract_f32 v53, v53
    v_fract_f32 v55, v55
    v_cos_f32 v26, v51
    v_cos_f32 v28, v53
    v_cos_f32 v30, v55
    v_sin_f32 v27, v51
    v_sin_f32 v29, v53
    v_sin_f32 v31, v55
    v_pk_mul_f32 v[26:27], v[26:27], v[50:51] op_sel:[0,0] op_sel_hi:[1,0]
    v_pk_mul_f32 v[28:29], v[28:29], v[52:53] op_sel:[0,0] op_sel_hi:[1,0]
    v_pk_mul_f32 v[30:31], v[30:31], v[54:55] op_sel:[0,0] op_sel_hi:[1,0]
    v_cvt_pk_bf16_f32 v22, v26, v27
    v_cvt_pk_bf16_f32 v23, v28, v29
    v_cvt_pk_bf16_f32 v24, v30, v31
    ds_write_addtid_b32 v22 offset:0
    ds_write_addtid_b32 v23 offset:16896
    ds_write_addtid_b32 v24 offset:33792
    buffer_load_dwordx2 v[104:105], v87, s[12:15], s79 offen
    s_add_u32 s79, s79, 5120
    v_pk_mul_f32 v[50:51], v[26:27], v[32:33] op_sel:[0,0] op_sel_hi:[1,0]
    v_pk_mul_f32 v[52:53], v[28:29], v[34:35] op_sel:[0,0] op_sel_hi:[1,0]
    v_pk_mul_f32 v[54:55], v[30:31], v[36:37] op_sel:[0,0] op_sel_hi:[1,0]
    v_pk_fma_f32 v[26:27], v[26:27], v[32:33], v[50:51] op_sel:[1,1,0] op_sel_hi:[0,1,1] neg_lo:[1,0,0]
    v_pk_fma_f32 v[28:29], v[28:29], v[34:35], v[52:53] op_sel:[1,1,0] op_sel_hi:[0,1,1] neg_lo:[1,0,0]
    v_pk_fma_f32 v[30:31], v[30:31], v[36:37], v[54:55] op_sel:[1,1,0] op_sel_hi:[0,1,1] neg_lo:[1,0,0]
    v_cvt_pk_bf16_f32 v22, v26, v27
    v_cvt_pk_bf16_f32 v23, v28, v29
    v_cvt_pk_bf16_f32 v24, v30, v31
    ds_write_addtid_b32 v22 offset:528
    ds_write_addtid_b32 v23 offset:17424
    ds_write_addtid_b32 v24 offset:34320
    buffer_load_dwordx2 v[106:107], v87, s[12:15], s79 offen
    s_add_u32 s79, s79, 5120
    v_pk_mul_f32 v[50:51], v[26:27], v[32:33] op_sel:[0,0] op_sel_hi:[1,0]
    v_pk_mul_f32 v[52:53], v[28:29], v[34:35] op_sel:[0,0] op_sel_hi:[1,0]
    v_pk_mul_f32 v[54:55], v[30:31], v[36:37] op_sel:[0,0] op_sel_hi:[1,0]
    v_pk_fma_f32 v[26:27], v[26:27], v[32:33], v[50:51] op_sel:[1,1,0] op_sel_hi:[0,1,1] neg_lo:[1,0,0]
    v_pk_fma_f32 v[28:29], v[28:29], v[34:35], v[52:53] op_sel:[1,1,0] op_sel_hi:[0,1,1] neg_lo:[1,0,0]
    v_pk_fma_f32 v[30:31], v[30:31], v[36:37], v[54:55] op_sel:[1,1,0] op_sel_hi:[0,1,1] neg_lo:[1,0,0]
    v_cvt_pk_bf16_f32 v22, v26, v27
    v_cvt_pk_bf16_f32 v23, v28, v29
    v_cvt_pk_bf16_f32 v24, v30, v31
    ds_write_addtid_b32 v22 offset:1056
    ds_write_addtid_b32 v23 offset:17952
    ds_write_addtid_b32 v24 offset:34848
    buffer_load_dwordx2 v[108:109], v87, s[12:15], s79 offen
    s_add_u32 s79, s79, 5120
    v_pk_mul_f32 v[50:51], v[26:27], v[32:33] op_sel:[0,0] op_sel_hi:[1,0]
    v_pk_mul_f32 v[52:53], v[28:29], v[34:35] op_sel:[0,0] op_sel_hi:[1,0]
    v_pk_mul_f32 v[54:55], v[30:31], v[36:37] op_sel:[0,0] op_sel_hi:[1,0]
    v_pk_fma_f32 v[26:27], v[26:27], v[32:33], v[50:51] op_sel:[1,1,0] op_sel_hi:[0,1,1] neg_lo:[1,0,0]
    v_pk_fma_f32 v[28:29], v[28:29], v[34:35], v[52:53] op_sel:[1,1,0] op_sel_hi:[0,1,1] neg_lo:[1,0,0]
    v_pk_fma_f32 v[30:31], v[30:31], v[36:37], v[54:55] op_sel:[1,1,0] op_sel_hi:[0,1,1] neg_lo:[1,0,0]
    v_cvt_pk_bf16_f32 v22, v26, v27
    v_cvt_pk_bf16_f32 v23, v28, v29
    v_cvt_pk_bf16_f32 v24, v30, v31
    ds_write_addtid_b32 v22 offset:1584
    ds_write_addtid_b32 v23 offset:18480
    ds_write_addtid_b32 v24 offset:35376
    buffer_load_dwordx2 v[110:111], v87, s[12:15], s79 offen
    v_pk_mul_f32 v[50:51], v[26:27], v[32:33] op_sel:[0,0] op_sel_hi:[1,0]
    v_pk_mul_f32 v[52:53], v[28:29], v[34:35] op_sel:[0,0] op_sel_hi:[1,0]
    v_pk_mul_f32 v[54:55], v[30:31], v[36:37] op_sel:[0,0] op_sel_hi:[1,0]
    v_pk_fma_f32 v[26:27], v[26:27], v[32:33], v[50:51] op_sel:[1,1,0] op_sel_hi:[0,1,1] neg_lo:[1,0,0]
    v_pk_fma_f32 v[28:29], v[28:29], v[34:35], v[52:53] op_sel:[1,1,0] op_sel_hi:[0,1,1] neg_lo:[1,0,0]
    v_pk_fma_f32 v[30:31], v[30:31], v[36:37], v[54:55] op_sel:[1,1,0] op_sel_hi:[0,1,1] neg_lo:[1,0,0]
    v_cvt_pk_bf16_f32 v22, v26, v27
    v_cvt_pk_bf16_f32 v23, v28, v29
    v_cvt_pk_bf16_f32 v24, v30, v31
    ds_write_addtid_b32 v22 offset:2112
    ds_write_addtid_b32 v23 offset:19008
    ds_write_addtid_b32 v24 offset:35904
    v_pk_mul_f32 v[50:51], v[26:27], v[32:33] op_sel:[0,0] op_sel_hi:[1,0]
    v_pk_mul_f32 v[52:53], v[28:29], v[34:35] op_sel:[0,0] op_sel_hi:[1,0]
    v_pk_mul_f32 v[54:55], v[30:31], v[36:37] op_sel:[0,0] op_sel_hi:[1,0]
    v_pk_fma_f32 v[26:27], v[26:27], v[32:33], v[50:51] op_sel:[1,1,0] op_sel_hi:[0,1,1] neg_lo:[1,0,0]
    v_pk_fma_f32 v[28:29], v[28:29], v[34:35], v[52:53] op_sel:[1,1,0] op_sel_hi:[0,1,1] neg_lo:[1,0,0]
    v_pk_fma_f32 v[30:31], v[30:31], v[36:37], v[54:55] op_sel:[1,1,0] op_sel_hi:[0,1,1] neg_lo:[1,0,0]
    v_cvt_pk_bf16_f32 v22, v26, v27
    v_cvt_pk_bf16_f32 v23, v28, v29
    v_cvt_pk_bf16_f32 v24, v30, v31
    ds_write_addtid_b32 v22 offset:2640
    ds_write_addtid_b32 v23 offset:19536
    ds_write_addtid_b32 v24 offset:36432
    v_pk_mul_f32 v[50:51], v[26:27], v[32:33] op_sel:[0,0] op_sel_hi:[1,0]
    v_pk_mul_f32 v[52:53], v[28:29], v[34:35] op_sel:[0,0] op_sel_hi:[1,0]
    v_pk_mul_f32 v[54:55], v[30:31], v[36:37] op_sel:[0,0] op_sel_hi:[1,0]
    v_pk_fma_f32 v[26:27], v[26:27], v[32:33], v[50:51] op_sel:[1,1,0] op_sel_hi:[0,1,1] neg_lo:[1,0,0]
    v_pk_fma_f32 v[28:29], v[28:29], v[34:35], v[52:53] op_sel:[1,1,0] op_sel_hi:[0,1,1] neg_lo:[1,0,0]
    v_pk_fma_f32 v[30:31], v[30:31], v[36:37], v[54:55] op_sel:[1,1,0] op_sel_hi:[0,1,1] neg_lo:[1,0,0]
    v_cvt_pk_bf16_f32 v22, v26, v27
    v_cvt_pk_bf16_f32 v23, v28, v29
    v_cvt_pk_bf16_f32 v24, v30, v31
    ds_write_addtid_b32 v22 offset:3168
    ds_write_addtid_b32 v23 offset:20064
    ds_write_addtid_b32 v24 offset:36960
    v_pk_mul_f32 v[50:51], v[26:27], v[32:33] op_sel:[0,0] op_sel_hi:[1,0]
    v_pk_mul_f32 v[52:53], v[28:29], v[34:35] op_sel:[0,0] op_sel_hi:[1,0]
    v_pk_mul_f32 v[54:55], v[30:31], v[36:37] op_sel:[0,0] op_sel_hi:[1,0]
    v_pk_fma_f32 v[26:27], v[26:27], v[32:33], v[50:51] op_sel:[1,1,0] op_sel_hi:[0,1,1] neg_lo:[1,0,0]
    v_pk_fma_f32 v[28:29], v[28:29], v[34:35], v[52:53] op_sel:[1,1,0] op_sel_hi:[0,1,1] neg_lo:[1,0,0]
    v_pk_fma_f32 v[30:31], v[30:31], v[36:37], v[54:55] op_sel:[1,1,0] op_sel_hi:[0,1,1] neg_lo:[1,0,0]
    v_cvt_pk_bf16_f32 v22, v26, v27
    v_cvt_pk_bf16_f32 v23, v28, v29
    v_cvt_pk_bf16_f32 v24, v30, v31
    ds_write_addtid_b32 v22 offset:3696
    ds_write_addtid_b32 v23 offset:20592
    ds_write_addtid_b32 v24 offset:37488
    v_pk_mul_f32 v[50:51], v[26:27], v[32:33] op_sel:[0,0] op_sel_hi:[1,0]
    v_pk_mul_f32 v[52:53], v[28:29], v[34:35] op_sel:[0,0] op_sel_hi:[1,0]
    v_pk_mul_f32 v[54:55], v[30:31], v[36:37] op_sel:[0,0] op_sel_hi:[1,0]
    v_pk_fma_f32 v[26:27], v[26:27], v[32:33], v[50:51] op_sel:[1,1,0] op_sel_hi:[0,1,1] neg_lo:[1,0,0]
    v_pk_fma_f32 v[28:29], v[28:29], v[34:35], v[52:53] op_sel:[1,1,0] op_sel_hi:[0,1,1] neg_lo:[1,0,0]
    v_pk_fma_f32 v[30:31], v[30:31], v[36:37], v[54:55] op_sel:[1,1,0] op_sel_hi:[0,1,1] neg_lo:[1,0,0]
    v_cvt_pk_bf16_f32 v22, v26, v27
    v_cvt_pk_bf16_f32 v23, v28, v29
    v_cvt_pk_bf16_f32 v24, v30, v31
    ds_write_addtid_b32 v22 offset:4224
    ds_write_addtid_b32 v23 offset:21120
    ds_write_addtid_b32 v24 offset:38016
    v_pk_mul_f32 v[50:51], v[26:27], v[32:33] op_sel:[0,0] op_sel_hi:[1,0]
    v_pk_mul_f32 v[52:53], v[28:29], v[34:35] op_sel:[0,0] op_sel_hi:[1,0]
    v_pk_mul_f32 v[54:55], v[30:31], v[36:37] op_sel:[0,0] op_sel_hi:[1,0]
    v_pk_fma_f32 v[26:27], v[26:27], v[32:33], v[50:51] op_sel:[1,1,0] op_sel_hi:[0,1,1] neg_lo:[1,0,0]
    v_pk_fma_f32 v[28:29], v[28:29], v[34:35], v[52:53] op_sel:[1,1,0] op_sel_hi:[0,1,1] neg_lo:[1,0,0]
    v_pk_fma_f32 v[30:31], v[30:31], v[36:37], v[54:55] op_sel:[1,1,0] op_sel_hi:[0,1,1] neg_lo:[1,0,0]
    v_cvt_pk_bf16_f32 v22, v26, v27
    v_cvt_pk_bf16_f32 v23, v28, v29
    v_cvt_pk_bf16_f32 v24, v30, v31
    ds_write_addtid_b32 v22 offset:4752
    ds_write_addtid_b32 v23 offset:21648
    ds_write_addtid_b32 v24 offset:38544
    v_pk_mul_f32 v[50:51], v[26:27], v[32:33] op_sel:[0,0] op_sel_hi:[1,0]
    v_pk_mul_f32 v[52:53], v[28:29], v[34:35] op_sel:[0,0] op_sel_hi:[1,0]
    v_pk_mul_f32 v[54:55], v[30:31], v[36:37] op_sel:[0,0] op_sel_hi:[1,0]
    v_pk_fma_f32 v[26:27], v[26:27], v[32:33], v[50:51] op_sel:[1,1,0] op_sel_hi:[0,1,1] neg_lo:[1,0,0]
    v_pk_fma_f32 v[28:29], v[28:29], v[34:35], v[52:53] op_sel:[1,1,0] op_sel_hi:[0,1,1] neg_lo:[1,0,0]
    v_pk_fma_f32 v[30:31], v[30:31], v[36:37], v[54:55] op_sel:[1,1,0] op_sel_hi:[0,1,1] neg_lo:[1,0,0]
    v_cvt_pk_bf16_f32 v22, v26, v27
    v_cvt_pk_bf16_f32 v23, v28, v29
    v_cvt_pk_bf16_f32 v24, v30, v31
    ds_write_addtid_b32 v22 offset:5280
    ds_write_addtid_b32 v23 offset:22176
    ds_write_addtid_b32 v24 offset:39072
    v_pk_mul_f32 v[50:51], v[26:27], v[32:33] op_sel:[0,0] op_sel_hi:[1,0]
    v_pk_mul_f32 v[52:53], v[28:29], v[34:35] op_sel:[0,0] op_sel_hi:[1,0]
    v_pk_mul_f32 v[54:55], v[30:31], v[36:37] op_sel:[0,0] op_sel_hi:[1,0]
    v_pk_fma_f32 v[26:27], v[26:27], v[32:33], v[50:51] op_sel:[1,1,0] op_sel_hi:[0,1,1] neg_lo:[1,0,0]
    v_pk_fma_f32 v[28:29], v[28:29], v[34:35], v[52:53] op_sel:[1,1,0] op_sel_hi:[0,1,1] neg_lo:[1,0,0]
    v_pk_fma_f32 v[30:31], v[30:31], v[36:37], v[54:55] op_sel:[1,1,0] op_sel_hi:[0,1,1] neg_lo:[1,0,0]
    v_cvt_pk_bf16_f32 v22, v26, v27
    v_cvt_pk_bf16_f32 v23, v28, v29
    v_cvt_pk_bf16_f32 v24, v30, v31
    ds_write_addtid_b32 v22 offset:5808
    ds_write_addtid_b32 v23 offset:22704
    ds_write_addtid_b32 v24 offset:39600
    v_pk_mul_f32 v[50:51], v[26:27], v[32:33] op_sel:[0,0] op_sel_hi:[1,0]
    v_pk_mul_f32 v[52:53], v[28:29], v[34:35] op_sel:[0,0] op_sel_hi:[1,0]
    v_pk_mul_f32 v[54:55], v[30:31], v[36:37] op_sel:[0,0] op_sel_hi:[1,0]
    v_pk_fma_f32 v[26:27], v[26:27], v[32:33], v[50:51] op_sel:[1,1,0] op_sel_hi:[0,1,1] neg_lo:[1,0,0]
    v_pk_fma_f32 v[28:29], v[28:29], v[34:35], v[52:53] op_sel:[1,1,0] op_sel_hi:[0,1,1] neg_lo:[1,0,0]
    v_pk_fma_f32 v[30:31], v[30:31], v[36:37], v[54:55] op_sel:[1,1,0] op_sel_hi:[0,1,1] neg_lo:[1,0,0]
    v_cvt_pk_bf16_f32 v22, v26, v27
    v_cvt_pk_bf16_f32 v23, v28, v29
    v_cvt_pk_bf16_f32 v24, v30, v31
    ds_write_addtid_b32 v22 offset:6336
    ds_write_addtid_b32 v23 offset:23232
    ds_write_addtid_b32 v24 offset:40128
    v_pk_mul_f32 v[50:51], v[26:27], v[32:33] op_sel:[0,0] op_sel_hi:[1,0]
    v_pk_mul_f32 v[52:53], v[28:29], v[34:35] op_sel:[0,0] op_sel_hi:[1,0]
    v_pk_mul_f32 v[54:55], v[30:31], v[36:37] op_sel:[0,0] op_sel_hi:[1,0]
    v_pk_fma_f32 v[26:27], v[26:27], v[32:33], v[50:51] op_sel:[1,1,0] op_sel_hi:[0,1,1] neg_lo:[1,0,0]
    v_pk_fma_f32 v[28:29], v[28:29], v[34:35], v[52:53] op_sel:[1,1,0] op_sel_hi:[0,1,1] neg_lo:[1,0,0]
    v_pk_fma_f32 v[30:31], v[30:31], v[36:37], v[54:55] op_sel:[1,1,0] op_sel_hi:[0,1,1] neg_lo:[1,0,0]
    v_cvt_pk_bf16_f32 v22, v26, v27
    v_cvt_pk_bf16_f32 v23, v28, v29
    v_cvt_pk_bf16_f32 v24, v30, v31
    ds_write_addtid_b32 v22 offset:6864
    ds_write_addtid_b32 v23 offset:23760
    ds_write_addtid_b32 v24 offset:40656
    v_pk_mul_f32 v[50:51], v[26:27], v[32:33] op_sel:[0,0] op_sel_hi:[1,0]
    v_pk_mul_f32 v[52:53], v[28:29], v[34:35] op_sel:[0,0] op_sel_hi:[1,0]
    v_pk_mul_f32 v[54:55], v[30:31], v[36:37] op_sel:[0,0] op_sel_hi:[1,0]
    v_pk_fma_f32 v[26:27], v[26:27], v[32:33], v[50:51] op_sel:[1,1,0] op_sel_hi:[0,1,1] neg_lo:[1,0,0]
    v_pk_fma_f32 v[28:29], v[28:29], v[34:35], v[52:53] op_sel:[1,1,0] op_sel_hi:[0,1,1] neg_lo:[1,0,0]
    v_pk_fma_f32 v[30:31], v[30:31], v[36:37], v[54:55] op_sel:[1,1,0] op_sel_hi:[0,1,1] neg_lo:[1,0,0]
    v_cvt_pk_bf16_f32 v22, v26, v27
    v_cvt_pk_bf16_f32 v23, v28, v29
    v_cvt_pk_bf16_f32 v24, v30, v31
    ds_write_addtid_b32 v22 offset:7392
    ds_write_addtid_b32 v23 offset:24288
    ds_write_addtid_b32 v24 offset:41184
    v_pk_mul_f32 v[50:51], v[26:27], v[32:33] op_sel:[0,0] op_sel_hi:[1,0]
    v_pk_mul_f32 v[52:53], v[28:29], v[34:35] op_sel:[0,0] op_sel_hi:[1,0]
    v_pk_mul_f32 v[54:55], v[30:31], v[36:37] op_sel:[0,0] op_sel_hi:[1,0]
    v_pk_fma_f32 v[26:27], v[26:27], v[32:33], v[50:51] op_sel:[1,1,0] op_sel_hi:[0,1,1] neg_lo:[1,0,0]
    v_pk_fma_f32 v[28:29], v[28:29], v[34:35], v[52:53] op_sel:[1,1,0] op_sel_hi:[0,1,1] neg_lo:[1,0,0]
    v_pk_fma_f32 v[30:31], v[30:31], v[36:37], v[54:55] op_sel:[1,1,0] op_sel_hi:[0,1,1] neg_lo:[1,0,0]
    v_cvt_pk_bf16_f32 v22, v26, v27
    v_cvt_pk_bf16_f32 v23, v28, v29
    v_cvt_pk_bf16_f32 v24, v30, v31
    ds_write_addtid_b32 v22 offset:7920
    ds_write_addtid_b32 v23 offset:24816
    ds_write_addtid_b32 v24 offset:41712
    s_waitcnt lgkmcnt(0)
    s_barrier
    buffer_load_dwordx4 v[112:115], v81, s[60:63], s74 offen offset:0 sc1
    buffer_load_dwordx4 v[116:119], v81, s[60:63], s74 offen offset:16 sc1
    buffer_load_dwordx4 v[120:123], v81, s[60:63], s74 offen offset:2048 sc1
    buffer_load_dwordx4 v[124:127], v81, s[60:63], s74 offen offset:2064 sc1
    v_and_b32_e64 v40, 1, v2
    v_bfe_u32 v41, v2, 4, 1
    v_lshrrev_b32_e64 v42, 5, v2
    v_bfe_u32 v43, v2, 2, 2
    v_bfe_u32 v44, v2, 2, 3
    v_lshl_add_u32 v45, v42, 3, v43
    v_and_b32_e64 v46, 3, v2
    v_bfe_u32 v47, v2, 1, 1
    v_and_b32_e64 v49, 31, v2
    v_lshrrev_b32 v50, 1, v2
    s_lshl_b32 s70, s64, 13
    s_add_u32 s70, s70, 131072
    v_lshl_add_u32 v50, v50, 7, s70
    v_lshl_add_u32 v88, v44, 4, v50
    v_lshl_add_u32 v88, v40, 3, v88
    v_lshlrev_b32_e64 v0, 11, v47
    v_lshl_add_u32 v0, v45, 7, v0
    v_lshl_add_u32 v0, v41, 4, v0
    v_lshrrev_b32_e64 v48, 1, v43
    v_lshl_add_u32 v48, v47, 1, v48
    v_xor_b32 v48, s64, v48
    v_and_b32 v48, 3, v48
    v_lshl_add_u32 v0, v48, 5, v0
    v_lshl_add_u32 v0, v40, 3, v0
    s_add_u32 s44, s100, 29360128
    s_addc_u32 s45, s101, 0
    s_mov_b32 s46, 2211840
    s_mov_b32 s47, 0x00020000
    v_lshl_add_u32 v50, v42, 2, v49
    v_add_u32 v50, 28, v50
    v_bfe_u32 v51, v50, 1, 3
    v_lshlrev_b32_e64 v3, 7, v50
    v_lshl_add_u32 v3, v51, 4, v3
    v_add_u32 v3, 119808, v3
    v_lshl_add_u32 v50, v41, 2, v46
    v_sub_u32 v50, v50, v45
    v_lshlrev_b32 v4, 3, v50
    v_add_u32 v4, 96, v4
    v_lshl_add_u32 v50, v42, 2, v46
    v_lshl_add_u32 v51, v42, 1, v47
    v_xor_b32 v51, 1, v51
    v_lshlrev_b32 v77, 7, v50
    v_lshl_add_u32 v77, v51, 4, v77
    v_lshl_add_u32 v77, v44, 1, v77
    v_add_u32 v77, 126976, v77
    v_cmp_eq_u32 vcc, 3, v46
    v_lshlrev_b32 v78, 2, v46
    v_add_u32 v78, 127236, v78
    v_mov_b32 v50, 126976
    v_cndmask_b32 v78, v78, v50, vcc
    v_lshrrev_b32 v79, 2, v2
    v_mul_u32_u24 v79, 40960, v79
    v_lshl_add_u32 v79, v46, 4, v79
    s_add_u32 s92, s100, 31981568
    s_addc_u32 s93, s101, 0
    s_mov_b32 s94, 24576
    s_mov_b32 s95, 0x00020000
    s_add_u32 s48, s100, 32505856
    s_addc_u32 s49, s101, 0
    s_mov_b32 s50, 221184
    s_mov_b32 s51, 0x00020000
    s_add_u32 s20, s100, 16777216
    s_addc_u32 s21, s101, 0
    s_mov_b32 s22, 2621440
    s_mov_b32 s23, 0x00020000
    s_mov_b32 s68, 0
    s_mov_b32 s69, 0x80000000
    s_cmp_eq_u32 s65, 3
    s_mov_b32 s70, 45417108
    s_cselect_b32 s70, 47579829, s70
    s_mov_b32 s71, 28115340
    s_cselect_b32 s71, 30278061, s71
    s_lshl_b32 s72, s64, 4
    s_lshr_b64 s[70:71], s[70:71], s72
    s_and_b32 s39, s70, 0xffff
    s_bfe_u32 s70, s39, 131072
    s_bfe_u32 s71, s39, 196610
    s_lshl_b32 s4, s70, 5
    s_lshl_b32 s5, s71, 12
    s_mul_i32 s6, s70, 4224
    s_add_u32 s6, s6, 114304
    s_lshr_b32 s24, s71, 1
    s_mul_i32 s25, s70, 5
    s_add_u32 s25, s25, s24
    s_lshl_b32 s25, s25, 4
    s_add_u32 s70, s70, s66
    s_lshl_b32 s70, s70, 6
    s_sub_u32 s71, s71, 1
    s_mul_i32 s26, s71, 327680
    s_add_u32 s26, s26, s70
    s_cmp_eq_u32 s24, 0
    s_cselect_b32 s27, 1, 0
    s_min_u32 s28, s24, 2
    s_bfe_u32 s70, s39, 131077
    s_bfe_u32 s71, s39, 196615
    s_lshl_b32 s29, s70, 5
    s_lshl_b32 s30, s71, 12
    s_mul_i32 s31, s70, 4224
    s_add_u32 s31, s31, 114304
    s_lshr_b32 s32, s71, 1
    s_mul_i32 s33, s70, 5
    s_add_u32 s33, s33, s32
    s_lshl_b32 s33, s33, 4
    s_add_u32 s70, s70, s66
    s_lshl_b32 s70, s70, 6
    s_sub_u32 s71, s71, 1
    s_mul_i32 s34, s71, 327680
    s_add_u32 s34, s34, s70
    s_cmp_eq_u32 s32, 0
    s_cselect_b32 s35, 1, 0
    s_min_u32 s36, s32, 2
    s_lshr_b32 s37, s39, 10
    s_cmp_lg_u32 s58, 0
    s_cbranch_scc1 L_m39
    v_mov_b32 v16, 0
    v_mov_b32 v17, 0
    v_mov_b32 v18, 0
    v_mov_b32 v19, 0
    v_mov_b32 v20, 83968
    ds_write_b128 v20, v[16:19]
L_m39:
    v_xor_b32 v65, 16, v88
    v_xor_b32 v66, 32, v88
    v_xor_b32 v67, 48, v88
    v_xor_b32 v68, 64, v88
    v_xor_b32 v69, 80, v88
    s_bitcmp1_b32 s66, 0
    s_mov_b32 s72, 0x01000c0c
    s_cselect_b32 s72, 0x03020c0c, s72
    s_mov_b32 s73, 0x05040100
    s_cselect_b32 s73, 0x07060302, s73
    s_waitcnt vmcnt(4)
    v_alignbit_b32 v40, v97, v96, 16
    v_alignbit_b32 v41, v99, v98, 16
    v_alignbit_b32 v42, v101, v100, 16
    v_alignbit_b32 v43, v103, v102, 16
    v_alignbit_b32 v44, v105, v104, 16
    v_alignbit_b32 v45, v107, v106, 16
    v_alignbit_b32 v46, v109, v108, 16
    v_alignbit_b32 v47, v111, v110, 16
    v_perm_b32 v48, v98, v96, s73
    v_perm_b32 v49, v102, v100, s73
    ds_write_b64 v65, v[48:49] offset:0
    v_perm_b32 v16, v96, v96, s72
    v_perm_b32 v17, v98, v98, s72
    v_perm_b32 v18, v100, v100, s72
    v_perm_b32 v19, v102, v102, s72
    v_perm_b32 v50, v41, v40, s73
    v_perm_b32 v51, v43, v42, s73
    ds_write_b64 v67, v[50:51] offset:0
    v_perm_b32 v24, v40, v40, s72
    v_perm_b32 v25, v41, v41, s72
    v_perm_b32 v26, v42, v42, s72
    v_perm_b32 v27, v43, v43, s72
    v_perm_b32 v52, v99, v97, s73
    v_perm_b32 v53, v103, v101, s73
    ds_write_b64 v69, v[52:53] offset:0
    v_perm_b32 v32, v97, v97, s72
    v_perm_b32 v33, v99, v99, s72
    v_perm_b32 v34, v101, v101, s72
    v_perm_b32 v35, v103, v103, s72
    v_perm_b32 v54, v106, v104, s73
    v_perm_b32 v55, v110, v108, s73
    ds_write_b64 v65, v[54:55] offset:4096
    v_perm_b32 v20, v104, v104, s72
    v_perm_b32 v21, v106, v106, s72
    v_perm_b32 v22, v108, v108, s72
    v_perm_b32 v23, v110, v110, s72
    v_perm_b32 v48, v45, v44, s73
    v_perm_b32 v49, v47, v46, s73
    ds_write_b64 v67, v[48:49] offset:4096
    v_perm_b32 v28, v44, v44, s72
    v_perm_b32 v29, v45, v45, s72
    v_perm_b32 v30, v46, v46, s72
    v_perm_b32 v31, v47, v47, s72
    v_perm_b32 v50, v107, v105, s73
    v_perm_b32 v51, v111, v109, s73
    ds_write_b64 v69, v[50:51] offset:4096
    v_perm_b32 v36, v105, v105, s72
    v_perm_b32 v37, v107, v107, s72
    v_perm_b32 v38, v109, v109, s72
    v_perm_b32 v39, v111, v111, s72
    s_mov_b32 s76, 0
    s_waitcnt vmcnt(0)
L_gl10:
    v_min3_u32 v40, v113, v115, v117
    v_max3_u32 v41, v113, v115, v117
    v_min3_u32 v40, v40, v119, v121
    v_max3_u32 v41, v41, v119, v121
    v_min3_u32 v40, v40, v123, v125
    v_max3_u32 v41, v41, v123, v125
    v_min_u32 v40, v40, v127
    v_max_u32 v41, v41, v127
    v_cmp_ne_u32_e64 vcc, s56, v40
    v_cmp_ne_u32 s[70:71], s56, v41
    s_add_u32 s76, s76, 1
    s_nop 0
    s_or_b64 s[70:71], s[70:71], vcc
    s_cbranch_scc0 L_gd11
    s_sleep 4
    buffer_load_dwordx4 v[112:115], v81, s[60:63], s74 offen offset:0 sc1
    buffer_load_dwordx4 v[116:119], v81, s[60:63], s74 offen offset:16 sc1
    buffer_load_dwordx4 v[120:123], v81, s[60:63], s74 offen offset:2048 sc1
    buffer_load_dwordx4 v[124:127], v81, s[60:63], s74 offen offset:2064 sc1
    s_cmp_lt_u32 s76, 20000
    s_waitcnt vmcnt(0)
    s_cbranch_scc1 L_gl10
L_gd11:
    v_mov_b32 v40, 127012
    v_mov_b32 v41, 1
    s_mov_b64 exec, 1
    ds_add_u32 v40, v41
    s_mov_b64 exec, -1
    v_and_b32 v48, 0xffff0000, v112
    v_and_b32 v49, 0xffff0000, v114
    v_and_b32 v50, 0xffff0000, v116
    v_and_b32 v51, 0xffff0000, v118
    v_and_b32 v52, 0xffff0000, v120
    v_and_b32 v53, 0xffff0000, v122
    v_and_b32 v54, 0xffff0000, v124
    v_and_b32 v55, 0xffff0000, v126
    v_rcp_f32 v48, v48
    v_rcp_f32 v49, v49
    v_rcp_f32 v50, v50
    v_rcp_f32 v51, v51
    v_rcp_f32 v52, v52
    v_rcp_f32 v53, v53
    v_rcp_f32 v54, v54
    v_rcp_f32 v55, v55
    v_lshlrev_b32 v56, 16, v112
    v_lshlrev_b32 v57, 16, v114
    v_lshlrev_b32 v58, 16, v116
    v_lshlrev_b32 v59, 16, v118
    v_lshlrev_b32 v60, 16, v120
    v_lshlrev_b32 v61, 16, v122
    v_lshlrev_b32 v62, 16, v124
    v_lshlrev_b32 v63, 16, v126
    v_pk_mul_f32 v[56:57], v[56:57], v[48:49] neg_lo:[1,0] neg_hi:[1,0]
    v_pk_mul_f32 v[58:59], v[58:59], v[50:51] neg_lo:[1,0] neg_hi:[1,0]
    v_pk_mul_f32 v[60:61], v[60:61], v[52:53] neg_lo:[1,0] neg_hi:[1,0]
    v_pk_mul_f32 v[62:63], v[62:63], v[54:55] neg_lo:[1,0] neg_hi:[1,0]
    v_pk_fma_f32 v[16:17], v[16:17], v[48:49], v[56:57]
    v_pk_fma_f32 v[18:19], v[18:19], v[50:51], v[58:59]
    v_pk_fma_f32 v[24:25], v[24:25], v[48:49], v[56:57]
    v_pk_fma_f32 v[26:27], v[26:27], v[50:51], v[58:59]
    v_pk_fma_f32 v[32:33], v[32:33], v[48:49], v[56:57]
    v_pk_fma_f32 v[34:35], v[34:35], v[50:51], v[58:59]
    v_cvt_pk_bf16_f32 v16, v16, v17
    v_cvt_pk_bf16_f32 v17, v18, v19
    ds_write_b64 v88, v[16:17] offset:0
    s_add_u32 s78, s67, 1603584
    buffer_load_dwordx4 v[212:215], v11, s[96:99], s78 offen
    s_add_u32 s78, s67, 1658880
    buffer_load_dwordx4 v[216:219], v11, s[96:99], s78 offen
    v_cvt_pk_bf16_f32 v24, v24, v25
    v_cvt_pk_bf16_f32 v25, v26, v27
    ds_write_b64 v66, v[24:25] offset:0
    s_add_u32 s78, s67, 1714176
    buffer_load_dwordx4 v[220:223], v11, s[96:99], s78 offen
    s_add_u32 s78, s67, 1769472
    buffer_load_dwordx4 v[224:227], v11, s[96:99], s78 offen
    v_cvt_pk_bf16_f32 v32, v32, v33
    v_cvt_pk_bf16_f32 v33, v34, v35
    ds_write_b64 v68, v[32:33] offset:0
    s_add_u32 s78, s67, 1824768
    buffer_load_dwordx4 v[228:231], v11, s[96:99], s78 offen
    s_add_u32 s78, s67, 1880064
    buffer_load_dwordx4 v[232:235], v11, s[96:99], s78 offen
    v_pk_fma_f32 v[20:21], v[20:21], v[52:53], v[60:61]
    v_pk_fma_f32 v[22:23], v[22:23], v[54:55], v[62:63]
    v_pk_fma_f32 v[28:29], v[28:29], v[52:53], v[60:61]
    v_pk_fma_f32 v[30:31], v[30:31], v[54:55], v[62:63]
    v_pk_fma_f32 v[36:37], v[36:37], v[52:53], v[60:61]
    v_pk_fma_f32 v[38:39], v[38:39], v[54:55], v[62:63]
    v_cvt_pk_bf16_f32 v20, v20, v21
    v_cvt_pk_bf16_f32 v21, v22, v23
    ds_write_b64 v88, v[20:21] offset:4096
    s_add_u32 s78, s67, 1935360
    buffer_load_dwordx4 v[236:239], v11, s[96:99], s78 offen
    s_add_u32 s78, s67, 1990656
    buffer_load_dwordx4 v[240:243], v11, s[96:99], s78 offen
    v_cvt_pk_bf16_f32 v28, v28, v29
    v_cvt_pk_bf16_f32 v29, v30, v31
    ds_write_b64 v66, v[28:29] offset:4096
    s_add_u32 s78, s67, 2045952
    buffer_load_dwordx4 v[244:247], v11, s[96:99], s78 offen
    s_add_u32 s78, s67, 2101248
    buffer_load_dwordx4 v[248:251], v11, s[96:99], s78 offen
    v_cvt_pk_bf16_f32 v36, v36, v37
    v_cvt_pk_bf16_f32 v37, v38, v39
    ds_write_b64 v68, v[36:37] offset:4096
    s_add_u32 s78, s67, 2156544
    buffer_load_dwordx4 v[252:255], v11, s[96:99], s78 offen
    s_cmp_eq_u32 s58, 0
    s_cbranch_scc1 L_nw12
    v_mov_b32 v40, 127012
    s_mov_b32 s87, 0
L_sp13:
    ds_read_b32 v41, v40
    s_add_u32 s87, s87, 1
    s_waitcnt lgkmcnt(0)
    v_readfirstlane_b32 s86, v41
    s_cmp_ge_u32 s86, 4
    s_cbranch_scc1 L_sd14
    s_cmp_lt_u32 s87, 200000
    s_cbranch_scc1 L_sp13
L_sd14:
    v_add_u32 v76, 65536, v0
    ds_read_b64_tr_b16 v[96:97], v76 offset:15360
    ds_read_b64_tr_b16 v[98:99], v76 offset:15872
    ds_read_b64_tr_b16 v[100:101], v76 offset:19456
    ds_read_b64_tr_b16 v[102:103], v76 offset:19968
    v_mov_b32 v72, 0
    s_mov_b32 exec_lo, 1048577
    s_mov_b32 exec_hi, 1048577
    v_mov_b32 v72, 0x3f803f80
    s_mov_b64 exec, -1
    v_mov_b32 v73, v72
    v_mov_b32_e64 v74, v72
    v_mov_b32 v75, v72
    s_waitcnt lgkmcnt(2)
    v_mfma_f32_16x16x32_bf16 v[12:15], v[72:75], v[96:99], 0
    s_waitcnt lgkmcnt(0)
    v_mfma_f32_16x16x32_bf16 v[12:15], v[72:75], v[100:103], v[12:15]
L_nw12:
    s_add_u32 s67, s67, 110592
    s_nop 6
    v_mov_b32 v13, v77
    v_mov_b32 v14, v78
    v_mov_b32 v15, v79
    v_xor_b32 v5, s4, v3
    v_add_u32 v7, s6, v4
    v_add_u32 v5, s5, v5
    v_xor_b32 v6, 64, v5
    v_xor_b32 v8, s4, v13
    v_add_u32 v10, s25, v14
    v_add_u32 v8, s5, v8
    v_xor_b32 v9, 64, v8
    s_xor_b32 s4, s4, 16
    s_add_u32 s5, s5, 126976
    s_mov_b32 m0, s84
    s_mul_i32 s38, s58, 110592
    s_waitcnt lgkmcnt(0)
    s_barrier
    ds_read_b128 v[64:67], v5 offset:3072
    ds_read_b64_tr_b16 v[80:81], v7 offset:32
    ds_read_b64_tr_b16 v[82:83], v7 offset:0
    ds_read_b128 v[68:71], v6 offset:2048
    ds_read_b64_tr_b16 v[84:85], v7 offset:160
    ds_read_b64_tr_b16 v[86:87], v7 offset:128
    ds_read_b128 v[72:75], v5 offset:1024
    ds_read_b64_tr_b16 v[88:89], v7 offset:288
    ds_read_b64_tr_b16 v[90:91], v7 offset:256
    ds_read_b128 v[76:79], v6 offset:0
    ds_read_b64_tr_b16 v[92:93], v7 offset:416
    ds_read_b64_tr_b16 v[94:95], v7 offset:384
    ds_read_b128 v[48:51], v5 offset:7168
    ds_read_b128 v[52:55], v6 offset:6144
    ds_read_b128 v[56:59], v5 offset:5120
    ds_read_b128 v[60:63], v6 offset:4096
    s_setprio 2
L_job15:
    s_waitcnt lgkmcnt(4)
    v_mfma_f32_32x32x16_bf16 v[32:47], v[64:67], v[80:83], 0
    v_subrev_u32 v5, 4096, v5
    v_subrev_u32 v6, 4096, v6
    v_add_u32 v7, 512, v7
    s_waitcnt lgkmcnt(3)
    s_cmp_lt_u32 m0, s38
    s_cbranch_scc0 L_dm21
    buffer_load_dwordx4 v11, s[96:99], s67 offen lds
    s_add_u32 m0, m0, 4096
    s_add_u32 s67, s67, 55296
L_dm21:
    v_mfma_f32_32x32x16_bf16 v[16:31], v[48:51], v[80:83], 0
    ds_read_b128 v[48:51], v5 offset:3072
    ds_read_b64_tr_b16 v[80:81], v7 offset:32
    ds_read_b64_tr_b16 v[82:83], v7 offset:0
    s_waitcnt lgkmcnt(5)
    v_mfma_f32_32x32x16_bf16 v[32:47], v[68:71], v[84:87], v[32:47]
    s_cmp_lt_u32 m0, s38
    s_cbranch_scc0 L_dm22
    buffer_load_dwordx4 v11, s[96:99], s67 offen lds
    s_add_u32 m0, m0, 4096
    s_add_u32 s67, s67, 55296
L_dm22:
    v_mfma_f32_32x32x16_bf16 v[16:31], v[52:55], v[84:87], v[16:31]
    ds_read_b128 v[52:55], v6 offset:2048
    ds_read_b64_tr_b16 v[84:85], v7 offset:160
    ds_read_b64_tr_b16 v[86:87], v7 offset:128
    s_waitcnt lgkmcnt(7)
    v_mfma_f32_32x32x16_bf16 v[32:47], v[72:75], v[88:91], v[32:47]
    s_cmp_lt_u32 m0, s38
    s_cbranch_scc0 L_dm23
    buffer_load_dwordx4 v11, s[96:99], s67 offen lds
    s_add_u32 m0, m0, 4096
    s_add_u32 s67, s67, 55296
L_dm23:
    v_mfma_f32_32x32x16_bf16 v[16:31], v[56:59], v[88:91], v[16:31]
    ds_read_b128 v[56:59], v5 offset:1024
    ds_read_b64_tr_b16 v[88:89], v7 offset:288
    ds_read_b64_tr_b16 v[90:91], v7 offset:256
    s_waitcnt lgkmcnt(9)
    v_mfma_f32_32x32x16_bf16 v[32:47], v[76:79], v[92:95], v[32:47]
    s_cmp_lt_u32 m0, s38
    s_cbranch_scc0 L_dm24
    buffer_load_dwordx4 v11, s[96:99], s67 offen lds
    s_add_u32 m0, m0, 4096
    s_add_u32 s67, s67, 55296
L_dm24:
    v_mfma_f32_32x32x16_bf16 v[16:31], v[60:63], v[92:95], v[16:31]
    ds_read_b128 v[60:63], v6 offset:0
    ds_read_b64_tr_b16 v[92:93], v7 offset:416
    ds_read_b64_tr_b16 v[94:95], v7 offset:384
    s_cmp_eq_u32 s24, 0
    s_cbranch_scc1 L_tail17
L_loop16:
    s_waitcnt lgkmcnt(9)
    v_mfma_f32_32x32x16_bf16 v[16:31], v[64:67], v[80:83], v[16:31]
    v_subrev_u32 v5, 4096, v5
    v_subrev_u32 v6, 4096, v6
    v_add_u32 v7, 512, v7
    ds_read_b128 v[64:67], v5 offset:3072
    s_cmp_lt_u32 m0, s38
    s_cbranch_scc0 L_dm25
    buffer_load_dwordx4 v11, s[96:99], s67 offen lds
    s_add_u32 m0, m0, 4096
    s_add_u32 s67, s67, 55296
L_dm25:
    v_mfma_f32_32x32x16_bf16 v[32:47], v[48:51], v[80:83], v[32:47]
    ds_read_b64_tr_b16 v[80:81], v7 offset:32
    ds_read_b64_tr_b16 v[82:83], v7 offset:0
    s_waitcnt lgkmcnt(9)
    v_mfma_f32_32x32x16_bf16 v[16:31], v[68:71], v[84:87], v[16:31]
    ds_read_b128 v[68:71], v6 offset:2048
    s_cmp_lt_u32 m0, s38
    s_cbranch_scc0 L_dm26
    buffer_load_dwordx4 v11, s[96:99], s67 offen lds
    s_add_u32 m0, m0, 4096
    s_add_u32 s67, s67, 55296
L_dm26:
    v_mfma_f32_32x32x16_bf16 v[32:47], v[52:55], v[84:87], v[32:47]
    ds_read_b64_tr_b16 v[84:85], v7 offset:160
    ds_read_b64_tr_b16 v[86:87], v7 offset:128
    s_waitcnt lgkmcnt(9)
    v_mfma_f32_32x32x16_bf16 v[16:31], v[72:75], v[88:91], v[16:31]
    ds_read_b128 v[72:75], v5 offset:1024
    s_cmp_lt_u32 m0, s38
    s_cbranch_scc0 L_dm27
    buffer_load_dwordx4 v11, s[96:99], s67 offen lds
    s_add_u32 m0, m0, 4096
    s_add_u32 s67, s67, 55296
L_dm27:
    v_mfma_f32_32x32x16_bf16 v[32:47], v[56:59], v[88:91], v[32:47]
    ds_read_b64_tr_b16 v[88:89], v7 offset:288
    ds_read_b64_tr_b16 v[90:91], v7 offset:256
    s_waitcnt lgkmcnt(9)
    v_mfma_f32_32x32x16_bf16 v[16:31], v[76:79], v[92:95], v[16:31]
    ds_read_b128 v[76:79], v6 offset:0
    s_cmp_lt_u32 m0, s38
    s_cbranch_scc0 L_dm28
    buffer_load_dwordx4 v11, s[96:99], s67 offen lds
    s_add_u32 m0, m0, 4096
    s_add_u32 s67, s67, 55296
L_dm28:
    v_mfma_f32_32x32x16_bf16 v[32:47], v[60:63], v[92:95], v[32:47]
    ds_read_b64_tr_b16 v[92:93], v7 offset:416
    ds_read_b64_tr_b16 v[94:95], v7 offset:384
    s_waitcnt lgkmcnt(9)
    v_mfma_f32_32x32x16_bf16 v[16:31], v[48:51], v[80:83], v[16:31]
    v_subrev_u32 v5, 4096, v5
    v_subrev_u32 v6, 4096, v6
    v_add_u32 v7, 512, v7
    ds_read_b128 v[48:51], v5 offset:3072
    s_cmp_lt_u32 m0, s38
    s_cbranch_scc0 L_dm29
    buffer_load_dwordx4 v11, s[96:99], s67 offen lds
    s_add_u32 m0, m0, 4096
    s_add_u32 s67, s67, 55296
L_dm29:
    v_mfma_f32_32x32x16_bf16 v[32:47], v[64:67], v[80:83], v[32:47]
    ds_read_b64_tr_b16 v[80:81], v7 offset:32
    ds_read_b64_tr_b16 v[82:83], v7 offset:0
    s_waitcnt lgkmcnt(9)
    v_mfma_f32_32x32x16_bf16 v[16:31], v[52:55], v[84:87], v[16:31]
    ds_read_b128 v[52:55], v6 offset:2048
    s_cmp_lt_u32 m0, s38
    s_cbranch_scc0 L_dm30
    buffer_load_dwordx4 v11, s[96:99], s67 offen lds
    s_add_u32 m0, m0, 4096
    s_add_u32 s67, s67, 55296
L_dm30:
    v_mfma_f32_32x32x16_bf16 v[32:47], v[68:71], v[84:87], v[32:47]
    ds_read_b64_tr_b16 v[84:85], v7 offset:160
    ds_read_b64_tr_b16 v[86:87], v7 offset:128
    s_waitcnt lgkmcnt(9)
    v_mfma_f32_32x32x16_bf16 v[16:31], v[56:59], v[88:91], v[16:31]
    ds_read_b128 v[56:59], v5 offset:1024
    s_cmp_lt_u32 m0, s38
    s_cbranch_scc0 L_dm31
    buffer_load_dwordx4 v11, s[96:99], s67 offen lds
    s_add_u32 m0, m0, 4096
    s_add_u32 s67, s67, 55296
L_dm31:
    v_mfma_f32_32x32x16_bf16 v[32:47], v[72:75], v[88:91], v[32:47]
    ds_read_b64_tr_b16 v[88:89], v7 offset:288
    ds_read_b64_tr_b16 v[90:91], v7 offset:256
    s_waitcnt lgkmcnt(9)
    v_mfma_f32_32x32x16_bf16 v[16:31], v[60:63], v[92:95], v[16:31]
    ds_read_b128 v[60:63], v6 offset:0
    s_cmp_lt_u32 m0, s38
    s_cbranch_scc0 L_dm32
    buffer_load_dwordx4 v11, s[96:99], s67 offen lds
    s_add_u32 m0, m0, 4096
    s_add_u32 s67, s67, 55296
L_dm32:
    v_mfma_f32_32x32x16_bf16 v[32:47], v[76:79], v[92:95], v[32:47]
    ds_read_b64_tr_b16 v[92:93], v7 offset:416
    ds_read_b64_tr_b16 v[94:95], v7 offset:384
    s_sub_u32 s24, s24, 1
    s_cmp_lg_u32 s24, 0
    s_cbranch_scc1 L_loop16
L_tail17:
    s_waitcnt lgkmcnt(9)
    v_mfma_f32_32x32x16_bf16 v[16:31], v[64:67], v[80:83], v[16:31]
    v_xor_b32 v5, s29, v3
    v_add_u32 v7, s31, v4
    v_add_u32 v5, s30, v5
    v_xor_b32_e64 v6, 64, v5
    ds_read_b128 v[64:67], v5 offset:3072
    ds_read_b64_tr_b16 v[80:81], v7 offset:32
    ds_read_b64_tr_b16 v[82:83], v7 offset:0
    ds_read_u16_d16_hi v48, v8 offset:0
    ds_read_u16_d16_hi v49, v9 offset:1024
    s_cmp_lt_u32 m0, s38
    s_cbranch_scc0 L_dm33
    buffer_load_dwordx4 v11, s[96:99], s67 offen lds
    s_add_u32 m0, m0, 4096
    s_add_u32 s67, s67, 55296
L_dm33:
    s_waitcnt lgkmcnt(11)
    v_mfma_f32_32x32x16_bf16 v[16:31], v[68:71], v[84:87], v[16:31]
    ds_read_b128 v[68:71], v6 offset:2048
    ds_read_b64_tr_b16 v[84:85], v7 offset:160
    ds_read_b64_tr_b16 v[86:87], v7 offset:128
    ds_read_u16_d16_hi v50, v8 offset:2048
    ds_read_u16_d16_hi v51, v9 offset:3072
    s_cmp_lt_u32 m0, s38
    s_cbranch_scc0 L_dm34
    buffer_load_dwordx4 v11, s[96:99], s67 offen lds
    s_add_u32 m0, m0, 4096
    s_add_u32 s67, s67, 55296
L_dm34:
    s_waitcnt lgkmcnt(13)
    v_mfma_f32_32x32x16_bf16 v[16:31], v[72:75], v[88:91], v[16:31]
    ds_read_b128 v[72:75], v5 offset:1024
    ds_read_b64_tr_b16 v[88:89], v7 offset:288
    ds_read_b64_tr_b16 v[90:91], v7 offset:256
    ds_read_u16_d16_hi v52, v8 offset:4096
    ds_read_u16_d16_hi v53, v9 offset:5120
    s_cmp_lt_u32 m0, s38
    s_cbranch_scc0 L_dm35
    buffer_load_dwordx4 v11, s[96:99], s67 offen lds
    s_add_u32 m0, m0, 4096
    s_add_u32 s67, s67, 55296
L_dm35:
    s_waitcnt lgkmcnt(15)
    v_mfma_f32_32x32x16_bf16 v[16:31], v[76:79], v[92:95], v[16:31]
    ds_read_b128 v[76:79], v6 offset:0
    ds_read_b64_tr_b16 v[92:93], v7 offset:416
    ds_read_b64_tr_b16 v[94:95], v7 offset:384
    ds_read_u16_d16_hi v54, v8 offset:6144
    ds_read_u16_d16_hi v55, v9 offset:7168
    s_cmp_lt_u32 m0, s38
    s_cbranch_scc0 L_dm36
    buffer_load_dwordx4 v11, s[96:99], s67 offen lds
    s_add_u32 m0, m0, 4096
    s_add_u32 s67, s67, 55296
L_dm36:
    ds_read_b32 v56, v10
    v_cndmask_b32 v57, v47, v43, s[68:69]
    v_cndmask_b32 v43, v43, v39, s[68:69]
    v_cndmask_b32 v39, v39, v35, s[68:69]
    v_add_f32_dpp v34, v35, v34 wave_shr:1 row_mask:0xf bank_mask:0xf bound_ctrl:0
    v_add_f32_dpp v46, v57, v46 wave_ror:1 row_mask:0xf bank_mask:0xf
    v_add_f32_dpp v42, v43, v42 wave_ror:1 row_mask:0xf bank_mask:0xf
    v_add_f32_dpp v38, v39, v38 wave_ror:1 row_mask:0xf bank_mask:0xf
    v_cndmask_b32 v57, v46, v42, s[68:69]
    v_cndmask_b32 v42, v42, v38, s[68:69]
    v_cndmask_b32 v38, v38, v34, s[68:69]
    v_add_f32_dpp v33, v34, v33 wave_shr:1 row_mask:0xf bank_mask:0xf bound_ctrl:0
    v_add_f32_dpp v45, v57, v45 wave_ror:1 row_mask:0xf bank_mask:0xf
    v_add_f32_dpp v41, v42, v41 wave_ror:1 row_mask:0xf bank_mask:0xf
    v_add_f32_dpp v37, v38, v37 wave_ror:1 row_mask:0xf bank_mask:0xf
    v_cndmask_b32 v57, v45, v41, s[68:69]
    v_cndmask_b32 v41, v41, v37, s[68:69]
    v_cndmask_b32 v37, v37, v33, s[68:69]
    v_add_f32_dpp v32, v33, v32 wave_shr:1 row_mask:0xf bank_mask:0xf bound_ctrl:0
    v_add_f32_dpp v44, v57, v44 wave_ror:1 row_mask:0xf bank_mask:0xf
    v_add_f32_dpp v40, v41, v40 wave_ror:1 row_mask:0xf bank_mask:0xf
    v_add_f32_dpp v36, v37, v36 wave_ror:1 row_mask:0xf bank_mask:0xf
    v_cndmask_b32 v57, v31, v27, s[68:69]
    v_cndmask_b32 v27, v27, v23, s[68:69]
    v_cndmask_b32 v23, v23, v19, s[68:69]
    v_cndmask_b32 v19, v19, v47, s[68:69]
    v_add_f32_dpp v30, v57, v30 wave_ror:1 row_mask:0xf bank_mask:0xf
    v_add_f32_dpp v26, v27, v26 wave_ror:1 row_mask:0xf bank_mask:0xf
    v_add_f32_dpp v22, v23, v22 wave_ror:1 row_mask:0xf bank_mask:0xf
    v_add_f32_dpp v18, v19, v18 wave_ror:1 row_mask:0xf bank_mask:0xf
    v_cndmask_b32 v57, v30, v26, s[68:69]
    v_cndmask_b32 v26, v26, v22, s[68:69]
    v_cndmask_b32 v22, v22, v18, s[68:69]
    v_cndmask_b32 v18, v18, v46, s[68:69]
    v_add_f32_dpp v29, v57, v29 wave_ror:1 row_mask:0xf bank_mask:0xf
    v_add_f32_dpp v25, v26, v25 wave_ror:1 row_mask:0xf bank_mask:0xf
    v_add_f32_dpp v21, v22, v21 wave_ror:1 row_mask:0xf bank_mask:0xf
    v_add_f32_dpp v17, v18, v17 wave_ror:1 row_mask:0xf bank_mask:0xf
    v_cndmask_b32 v57, v29, v25, s[68:69]
    v_cndmask_b32 v25, v25, v21, s[68:69]
    v_cndmask_b32 v21, v21, v17, s[68:69]
    v_cndmask_b32 v17, v17, v45, s[68:69]
    v_add_f32_dpp v28, v57, v28 wave_ror:1 row_mask:0xf bank_mask:0xf
    v_add_f32_dpp v24, v25, v24 wave_ror:1 row_mask:0xf bank_mask:0xf
    v_add_f32_dpp v20, v21, v20 wave_ror:1 row_mask:0xf bank_mask:0xf
    v_add_f32_dpp v16, v17, v16 wave_ror:1 row_mask:0xf bank_mask:0xf
    s_mov_b64 exec, s[68:69]
    ds_write_b128 v10, v[28:31] offset:272
    ds_write_b32 v10, v2 offset:16
    s_mov_b64 exec, -1
    v_bfe_u32 v38, v2, 1, 3
    v_lshl_add_u32 v39, v2, 7, s5
    v_lshlrev_b32 v38, 4, v38
    v_xor_b32_e64 v38, s4, v38
    v_add_u32 v38, v38, v39
    s_waitcnt lgkmcnt(2)
    v_readlane_b32 s86, v56, 3
    v_add_f32 v32, v32, v48
    v_add_f32 v36, v36, v49
    v_add_f32_e64 v40, v40, v50
    v_add_f32 v44, v44, v51
    s_or_b32 s86, s86, s27
    s_cbranch_scc1 L_ok18
    s_mov_b32 s87, 0
L_sp19:
    ds_read_b32 v56, v10
    s_add_u32 s87, s87, 1
    s_waitcnt lgkmcnt(0)
    v_readlane_b32 s86, v56, 3
    s_cmp_lg_u32 s86, 0
    s_cbranch_scc1 L_ok18
    s_sleep 1
    s_cmp_lt_u32 s87, 200000
    s_cbranch_scc1 L_sp19
L_ok18:
    v_add_f32 v16, v16, v52
    v_add_f32 v20, v20, v53
    v_add_f32_e64 v24, v24, v54
    v_add_f32 v28, v28, v55
    s_mov_b64 exec, 7
    v_add_f32 v32, v32, v56
    s_mov_b64 exec, -1
    v_cvt_pk_bf16_f32 v33, v32, v36
    ds_read_b128 v[48:51], v5 offset:7168
    v_cvt_pk_bf16_f32 v34, v40, v44
    ds_read_b128 v[52:55], v6 offset:6144
    v_cvt_pk_bf16_f32 v35, v16, v20
    ds_read_b128 v[56:59], v5 offset:5120
    v_cvt_pk_bf16_f32 v37, v24, v28
    ds_read_b128 v[60:63], v6 offset:4096
    ds_write_b16 v8, v33 offset:0
    ds_write_b16_d16_hi v9, v33 offset:1024
    ds_write_b16 v8, v34 offset:2048
    ds_write_b16_d16_hi v9, v34 offset:3072
    ds_write_b16 v8, v35 offset:4096
    ds_write_b16_d16_hi v9, v35 offset:5120
    ds_write_b16 v8, v37 offset:6144
    ds_write_b16_d16_hi v9, v37 offset:7168
    ds_read_b128 v[40:43], v38
    s_waitcnt lgkmcnt(0)
    buffer_store_dwordx4 v[40:43], v15, s[20:23], s26 offen sc1
    s_cmp_lg_u32 s37, 1
    s_cbranch_scc1 L_fin20
    s_mov_b32 s37, 2
    s_mov_b32 s40, s28
    s_mov_b32 s24, s32
    s_mov_b32 s26, s34
    s_mov_b32 s27, s35
    s_mov_b32 s28, s36
    v_xor_b32 v8, s29, v13
    v_add_u32 v10, s33, v14
    v_add_u32 v8, s30, v8
    v_xor_b32 v9, 64, v8
    s_xor_b32 s4, s29, 16
    s_add_u32 s5, s30, 126976
    s_branch L_job15
L_fin20:
    s_waitcnt lgkmcnt(0)
    s_mov_b32 s70, m0
L_lo37:
    s_cmp_lt_u32 m0, s38
    s_cbranch_scc0 L_ld38
    buffer_load_dwordx4 v11, s[96:99], s67 offen lds
    s_add_u32 m0, m0, 4096
    s_add_u32 s67, s67, 55296
    s_branch L_lo37
L_ld38:
    s_sub_u32 s70, m0, s70
    s_cmp_lt_u32 s70, 77824
    s_cbranch_scc1 L_wn40
    s_waitcnt vmcnt(19)
    s_branch L_wd39
L_wn40:
    s_cmp_lt_u32 s70, 45056
    s_cbranch_scc1 L_wn41
    s_waitcnt vmcnt(11)
    s_branch L_wd39
L_wn41:
    s_cmp_lt_u32 s70, 12288
    s_cbranch_scc1 L_wn42
    s_waitcnt vmcnt(3)
    s_branch L_wd39
L_wn42:
    s_waitcnt vmcnt(0)
L_wd39:
    s_lshl_b32 s85, s28, 2
    s_add_u32 s85, s85, 126980
    v_mov_b32_e64 v58, s85
    v_mov_b32 v59, 1
    s_mov_b64 exec, 1
    ds_add_rtn_u32 v59, v58, v59
    s_waitcnt lgkmcnt(0)
    v_readfirstlane_b32 s86, v59
    s_mov_b64 exec, -1
    s_lshr_b32 s85, s28, 1
    s_add_u32 s86, s86, 1
    s_lshl_b32 s85, s65, s85
    s_cmp_eq_u32 s28, 0
    s_cselect_b32 s85, 4, s85
    s_cmp_lg_u32 s86, s85
    s_cselect_b32 s85, 0x7ff00000, 0
    v_lshl_add_u32 v58, v2, 10, s85
    v_mov_b32 v59, s56
    s_lshl_b32 s86, s2, 2
    s_lshl_b32 s85, s28, 13
    s_add_u32 s86, s86, s85
    s_mov_b64 exec, 0xff
    buffer_store_dword v59, v58, s[92:95], s86 offen sc1
    s_mov_b64 exec, -1
L_nf43:
    s_mov_b32 s30, s64
    s_mov_b32 s32, s57
    s_and_b32 s31, s2, 1
    s_lshl_b32 s31, s31, 2
    s_bfe_u32 s33, s2, 0x20003
    s_add_u32 s31, s31, s33
    s_add_u32 s24, s100, 19922944
    s_addc_u32 s25, s101, 0
    s_mov_b32 s26, 32768
    s_mov_b32 s27, 0x00020000
    s_add_u32 s40, s100, 20971520
    s_addc_u32 s41, s101, 0
    s_mov_b32 s42, 7077888
    s_mov_b32 s43, 0x00020000
    s_and_b32 s8, s2, 7
    s_lshl_b32 s8, s8, 10
    s_add_u32 s9, s8, 8192
    s_add_u32 s10, s8, 16384
    s_and_b32 s66, s2, 7
    s_bfe_u32 s67, s2, 0x30003
    s_lshr_b32 s59, s2, 6
    s_lshl_b32 s72, s66, 4
    s_add_u32 s72, s72, s59
    s_mul_i32 s72, s72, 55296
    s_add_u32 s73, s72, 221184
    s_add_u32 s74, s72, 442368
    s_add_u32 s75, s72, 663552
    s_lshr_b32 s76, s59, 1
    s_mul_i32 s76, s76, 40960
    s_and_b32 s77, s59, 1
    s_mul_i32 s77, s77, 2560
    s_add_u32 s76, s76, s77
    s_mul_i32 s77, s67, 160
    s_add_u32 s76, s76, s77
    s_mul_i32 s77, s66, 81920
    s_add_u32 s76, s76, s77
    s_add_u32 s78, s76, s77
    s_add_u32 s77, s76, 655360
    s_add_u32 s79, s78, 1392640
    s_add_u32 s78, s78, 1310720
    s_lshl_b32 s4, s66, 3
    s_lshr_b32 s5, s59, 1
    s_add_u32 s4, s4, s5
    s_mul_i32 s4, s4, 3456
    s_add_u32 s5, s4, 6912
    s_add_u32 s6, s4, 13824
    s_add_u32 s7, s4, 20736
    v_lshlrev_b32_e64 v32, 4, v2
    v_bfe_u32 v34, v2, 2, 2
    v_lshrrev_b32_e64 v35, 5, v2
    v_lshl_add_u32 v35, v35, 3, v34
    v_and_b32_e64 v34, 3, v2
    v_bfe_u32 v36, v2, 4, 1
    v_lshlrev_b32_e64 v4, 6, v35
    v_lshl_add_u32 v4, v36, 5, v4
    v_lshl_add_u32 v4, v34, 3, v4
    v_add_u32 v5, 40960, v4
    v_and_b32 v34, 31, v2
    v_lshlrev_b32 v6, 4, v34
    v_add_u32 v6, 81408, v6
    v_mul_u32_u24 v8, 55296, v36
    v_lshrrev_b32_e64 v34, 5, v2
    v_lshl_add_u32 v8, v34, 8, v8
    v_and_b32_e64 v34, 15, v2
    v_lshl_add_u32 v8, v34, 4, v8
    s_and_b32 s35, s30, 1
    s_lshl_b32 s35, s35, 9
    v_add_u32_e64 v8, s35, v8
    v_mov_b32 v7, 0x7ff00000
    s_mul_i32 s36, s31, 884736
    s_lshl_b32 s35, s32, 1
    s_lshr_b32 s37, s30, 1
    s_add_u32 s35, s35, s37
    s_lshl_b32 s35, s35, 10
    s_add_u32 s36, s36, s35
    s_mov_b32 s39, 0
    s_mul_i32 s29, s31, 216
    s_add_u32 s29, s29, s32
    s_lshl_b32 s29, s29, 5
    s_add_u32 s29, s29, s30
    s_lshl_b32 s29, s29, 2
    s_sub_u32 s29, s29, 6912
    v_mov_b32 v24, 0
    v_mov_b32 v25, 0
    v_mov_b32 v26, 0
    v_mov_b32 v27, 0
    v_mov_b32 v61, 0
    v_mov_b32 v62, 0
    v_mov_b32_e64 v63, 0
    v_add_u32 v33, 4096, v32
    s_mul_i32 s34, s30, 5120
    s_mul_i32 s33, s31, 81920
    s_add_u32 s33, s33, s34
    v_mov_b32 v11, s56
    v_mov_b32 v9, 0x7ff00000
    v_cmp_eq_u32_e64 vcc, 0, v2
    s_mov_b32 s37, 0
    s_mov_b32 m0, s34
    v_cndmask_b32 v10, v9, v2, vcc
    s_lshl_b32 s35, s30, 10
    s_add_u32 s35, s35, 61440
    v_add_u32 v36, s35, v32
    s_cmp_eq_u32 s58, 0
    s_cbranch_scc1 L_nw44
    s_waitcnt vmcnt(1)
    v_mov_b32 v58, 126996
    v_mov_b32 v59, 1
    s_mov_b64 exec, 1
    ds_add_u32 v58, v59
    s_mov_b64 exec, -1
    s_cmp_lg_u32 s64, 0
    s_cbranch_scc1 L_mf45
    buffer_load_dwordx4 v[28:31], v32, s[92:95], s8 offen sc1
L_mf45:
    s_mov_b32 s87, 0
L_sp46:
    ds_read_b32 v59, v58
    s_add_u32 s87, s87, 1
    s_waitcnt lgkmcnt(0)
    v_readfirstlane_b32 s86, v59
    s_cmp_ge_u32 s86, 4
    s_cbranch_scc1 L_sd47
    s_cmp_lt_u32 s87, 200000
    s_cbranch_scc1 L_sp46
L_sd47:
    v_add_u32 v20, 65536, v0
    ds_read_b64_tr_b16 v[104:105], v0 offset:0
    ds_read_b64_tr_b16 v[106:107], v0 offset:512
    ds_read_b64_tr_b16 v[108:109], v0 offset:4096
    ds_read_b64_tr_b16 v[110:111], v0 offset:4608
    v_mov_b32_e64 v16, 0
    s_mov_b32 exec_lo, 1048577
    s_mov_b32 exec_hi, 1048577
    v_mov_b32 v16, 0x3f803f80
    s_mov_b64 exec, -1
    v_mov_b32 v17, v16
    v_mov_b32 v18, v16
    v_mov_b32 v19, v16
    ds_read_b64_tr_b16 v[112:113], v0 offset:8192
    ds_read_b64_tr_b16 v[114:115], v0 offset:8704
    ds_read_b64_tr_b16 v[116:117], v0 offset:12288
    ds_read_b64_tr_b16 v[118:119], v0 offset:12800
    ds_read_b64_tr_b16 v[120:121], v0 offset:16384
    ds_read_b64_tr_b16 v[122:123], v0 offset:16896
    ds_read_b64_tr_b16 v[124:125], v0 offset:20480
    ds_read_b64_tr_b16 v[126:127], v0 offset:20992
    ds_read_b64_tr_b16 v[128:129], v0 offset:24576
    ds_read_b64_tr_b16 v[130:131], v0 offset:25088
    s_waitcnt lgkmcnt(12)
    v_mfma_f32_16x16x32_bf16 v[12:15], v[16:19], v[104:107], v[12:15]
    ds_read_b64_tr_b16 v[132:133], v0 offset:28672
    ds_read_b64_tr_b16 v[134:135], v0 offset:29184
    s_waitcnt lgkmcnt(12)
    v_mfma_f32_16x16x32_bf16 v[12:15], v[16:19], v[108:111], v[12:15]
    ds_read_b64_tr_b16 v[136:137], v0 offset:32768
    ds_read_b64_tr_b16 v[138:139], v0 offset:33280
    s_waitcnt lgkmcnt(12)
    v_mfma_f32_16x16x32_bf16 v[12:15], v[16:19], v[112:115], v[12:15]
    ds_read_b64_tr_b16 v[140:141], v0 offset:36864
    ds_read_b64_tr_b16 v[142:143], v0 offset:37376
    s_waitcnt lgkmcnt(12)
    v_mfma_f32_16x16x32_bf16 v[12:15], v[16:19], v[116:119], v[12:15]
    ds_read_b64_tr_b16 v[144:145], v0 offset:40960
    ds_read_b64_tr_b16 v[146:147], v0 offset:41472
    s_waitcnt lgkmcnt(12)
    v_mfma_f32_16x16x32_bf16 v[12:15], v[16:19], v[120:123], v[12:15]
    ds_read_b64_tr_b16 v[148:149], v0 offset:45056
    ds_read_b64_tr_b16 v[150:151], v0 offset:45568
    s_waitcnt lgkmcnt(12)
    v_mfma_f32_16x16x32_bf16 v[12:15], v[16:19], v[124:127], v[12:15]
    ds_read_b64_tr_b16 v[152:153], v0 offset:49152
    ds_read_b64_tr_b16 v[154:155], v0 offset:49664
    s_waitcnt lgkmcnt(12)
    v_mfma_f32_16x16x32_bf16 v[12:15], v[16:19], v[128:131], v[12:15]
    ds_read_b64_tr_b16 v[156:157], v0 offset:53248
    ds_read_b64_tr_b16 v[158:159], v0 offset:53760
    s_waitcnt lgkmcnt(12)
    v_mfma_f32_16x16x32_bf16 v[12:15], v[16:19], v[132:135], v[12:15]
    ds_read_b64_tr_b16 v[160:161], v0 offset:57344
    ds_read_b64_tr_b16 v[162:163], v0 offset:57856
    s_waitcnt lgkmcnt(12)
    v_mfma_f32_16x16x32_bf16 v[12:15], v[16:19], v[136:139], v[12:15]
    ds_read_b64_tr_b16 v[164:165], v0 offset:61440
    ds_read_b64_tr_b16 v[166:167], v0 offset:61952
    s_waitcnt lgkmcnt(12)
    v_mfma_f32_16x16x32_bf16 v[12:15], v[16:19], v[140:143], v[12:15]
    ds_read_b64_tr_b16 v[168:169], v20 offset:0
    ds_read_b64_tr_b16 v[170:171], v20 offset:512
    s_waitcnt lgkmcnt(12)
    v_mfma_f32_16x16x32_bf16 v[12:15], v[16:19], v[144:147], v[12:15]
    ds_read_b64_tr_b16 v[172:173], v20 offset:4096
    ds_read_b64_tr_b16 v[174:175], v20 offset:4608
    s_waitcnt lgkmcnt(12)
    v_mfma_f32_16x16x32_bf16 v[12:15], v[16:19], v[148:151], v[12:15]
    ds_read_b64_tr_b16 v[176:177], v20 offset:8192
    ds_read_b64_tr_b16 v[178:179], v20 offset:8704
    s_waitcnt lgkmcnt(12)
    v_mfma_f32_16x16x32_bf16 v[12:15], v[16:19], v[152:155], v[12:15]
    ds_read_b64_tr_b16 v[180:181], v20 offset:12288
    ds_read_b64_tr_b16 v[182:183], v20 offset:12800
    s_waitcnt lgkmcnt(12)
    v_mfma_f32_16x16x32_bf16 v[12:15], v[16:19], v[156:159], v[12:15]
    ds_read_b64_tr_b16 v[184:185], v20 offset:16384
    ds_read_b64_tr_b16 v[186:187], v20 offset:16896
    s_waitcnt lgkmcnt(12)
    v_mfma_f32_16x16x32_bf16 v[12:15], v[16:19], v[160:163], v[12:15]
    ds_read_b64_tr_b16 v[188:189], v20 offset:20480
    ds_read_b64_tr_b16 v[190:191], v20 offset:20992
    s_waitcnt lgkmcnt(12)
    v_mfma_f32_16x16x32_bf16 v[12:15], v[16:19], v[164:167], v[12:15]
    ds_read_b64_tr_b16 v[192:193], v20 offset:24576
    ds_read_b64_tr_b16 v[194:195], v20 offset:25088
    s_waitcnt lgkmcnt(12)
    v_mfma_f32_16x16x32_bf16 v[12:15], v[16:19], v[168:171], v[12:15]
    ds_read_b64_tr_b16 v[196:197], v20 offset:28672
    ds_read_b64_tr_b16 v[198:199], v20 offset:29184
    s_waitcnt lgkmcnt(12)
    v_mfma_f32_16x16x32_bf16 v[12:15], v[16:19], v[172:175], v[12:15]
    ds_read_b64_tr_b16 v[200:201], v20 offset:32768
    ds_read_b64_tr_b16 v[202:203], v20 offset:33280
    s_waitcnt lgkmcnt(12)
    v_mfma_f32_16x16x32_bf16 v[12:15], v[16:19], v[176:179], v[12:15]
    ds_read_b64_tr_b16 v[204:205], v20 offset:36864
    ds_read_b64_tr_b16 v[206:207], v20 offset:37376
    s_waitcnt lgkmcnt(12)
    v_mfma_f32_16x16x32_bf16 v[12:15], v[16:19], v[180:183], v[12:15]
    ds_read_b64_tr_b16 v[208:209], v20 offset:40960
    ds_read_b64_tr_b16 v[210:211], v20 offset:41472
    s_waitcnt lgkmcnt(12)
    v_mfma_f32_16x16x32_bf16 v[12:15], v[16:19], v[184:187], v[12:15]
    s_waitcnt lgkmcnt(10)
    v_mfma_f32_16x16x32_bf16 v[12:15], v[16:19], v[188:191], v[12:15]
    s_waitcnt lgkmcnt(8)
    v_mfma_f32_16x16x32_bf16 v[12:15], v[16:19], v[192:195], v[12:15]
    s_waitcnt lgkmcnt(6)
    v_mfma_f32_16x16x32_bf16 v[12:15], v[16:19], v[196:199], v[12:15]
    s_waitcnt lgkmcnt(4)
    v_mfma_f32_16x16x32_bf16 v[12:15], v[16:19], v[200:203], v[12:15]
    s_waitcnt lgkmcnt(2)
    v_mfma_f32_16x16x32_bf16 v[12:15], v[16:19], v[204:207], v[12:15]
    s_waitcnt lgkmcnt(0)
    v_mfma_f32_16x16x32_bf16 v[12:15], v[16:19], v[208:211], v[12:15]
L_nw44:
    s_and_b32 s8, s2, 7
    s_lshl_b32 s8, s8, 10
    v_lshlrev_b32 v32, 4, v2
    s_cmp_eq_u32 s58, 0
    s_cbranch_scc1 L_mc48
    s_cmp_lg_u32 s64, 0
    s_cbranch_scc1 L_mc48
    s_waitcnt vmcnt(0)
    s_mov_b32 s87, 0
L_pl49:
    v_xor_b32 v28, s56, v28
    v_xor_b32 v29, s56, v29
    v_xor_b32 v30, s56, v30
    v_xor_b32 v31, s56, v31
    v_or3_b32 v28, v28, v29, v30
    v_or_b32_e64 v28, v28, v31
    v_cmp_ne_u32 vcc, 0, v28
    s_add_u32 s87, s87, 1
    s_cbranch_vccz L_pd50
    s_sleep 4
    buffer_load_dwordx4 v[28:31], v32, s[92:95], s8 offen sc1
    s_cmp_lt_u32 s87, 20000
    s_waitcnt vmcnt(0)
    s_cbranch_scc1 L_pl49
L_pd50:
L_mc48:
    v_mov_b32 v58, 127000
    v_mov_b32 v59, 1
    s_mov_b64 exec, 1
    ds_add_u32 v58, v59
    s_mov_b64 exec, -1
    s_cmp_eq_u32 s58, 0
    s_cbranch_scc1 L_idle2
    s_mov_b32 s87, 0
L_sp51:
    ds_read_b32 v59, v58
    s_add_u32 s87, s87, 1
    s_waitcnt lgkmcnt(0)
    v_readfirstlane_b32 s86, v59
    s_cmp_ge_u32 s86, 4
    s_cbranch_scc1 L_sd52
    s_cmp_lt_u32 s87, 200000
    s_cbranch_scc1 L_sp51
L_sd52:
    buffer_load_dwordx4 v32, s[20:23], s33 offen offset:0 sc1 lds
    buffer_load_dwordx4 v32, s[20:23], s33 offen offset:1024 sc1 lds
    buffer_load_dwordx4 v32, s[20:23], s33 offen offset:2048 sc1 lds
    buffer_load_dwordx4 v32, s[20:23], s33 offen offset:3072 sc1 lds
    s_add_u32 m0, m0, 4096
    s_nop 0
    buffer_load_dwordx4 v33, s[20:23], s33 offen sc1 lds
    s_add_u32 m0, m0, 16384
    s_add_u32 s33, s33, 20480
    buffer_load_dwordx4 v32, s[20:23], s33 offen offset:0 sc1 lds
    buffer_load_dwordx4 v32, s[20:23], s33 offen offset:1024 sc1 lds
    buffer_load_dwordx4 v32, s[20:23], s33 offen offset:2048 sc1 lds
    buffer_load_dwordx4 v32, s[20:23], s33 offen offset:3072 sc1 lds
    s_add_u32 m0, m0, 4096
    s_nop 0
    buffer_load_dwordx4 v33, s[20:23], s33 offen sc1 lds
    ds_write_b128 v36, v[212:215] offset:24576
    ds_write_b128 v36, v[216:219] offset:28672
    ds_write_b128 v36, v[220:223] offset:32768
    ds_write_b128 v36, v[224:227] offset:36864
    ds_write_b128 v36, v[228:231] offset:40960
    ds_write_b128 v36, v[232:235] offset:45056
    ds_write_b128 v36, v[236:239] offset:0
    ds_write_b128 v36, v[240:243] offset:4096
    ds_write_b128 v36, v[244:247] offset:8192
    ds_write_b128 v36, v[248:251] offset:12288
    ds_write_b128 v36, v[252:255] offset:16384
    s_waitcnt lgkmcnt(0)
    v_mov_b32 v58, 127004
    v_mov_b32 v59, 1
    s_mov_b64 exec, 1
    ds_add_u32 v58, v59
    s_mov_b64 exec, -1
    s_mov_b32 s87, 0
L_sp53:
    ds_read_b32 v59, v58
    s_add_u32 s87, s87, 1
    s_waitcnt lgkmcnt(0)
    v_readfirstlane_b32 s86, v59
    s_cmp_ge_u32 s86, 4
    s_cbranch_scc1 L_sd54
    s_cmp_lt_u32 s87, 200000
    s_cbranch_scc1 L_sp53
L_sd54:
    v_add_u32 v20, 65536, v0
    ds_read_b64_tr_b16 v[212:213], v20 offset:20480
    ds_read_b64_tr_b16 v[214:215], v20 offset:20992
    ds_read_b64_tr_b16 v[216:217], v20 offset:24576
    ds_read_b64_tr_b16 v[218:219], v20 offset:25088
    v_mov_b32 v16, 0
    s_mov_b32 exec_lo, 1048577
    s_mov_b32 exec_hi, 1048577
    v_mov_b32 v16, 0x3f803f80
    s_mov_b64 exec, -1
    v_mov_b32 v17, v16
    v_mov_b32 v18, v16
    v_mov_b32 v19, v16
    ds_read_b64_tr_b16 v[220:221], v20 offset:28672
    ds_read_b64_tr_b16 v[222:223], v20 offset:29184
    ds_read_b64_tr_b16 v[224:225], v20 offset:32768
    ds_read_b64_tr_b16 v[226:227], v20 offset:33280
    ds_read_b64_tr_b16 v[228:229], v20 offset:36864
    ds_read_b64_tr_b16 v[230:231], v20 offset:37376
    ds_read_b64_tr_b16 v[232:233], v20 offset:40960
    ds_read_b64_tr_b16 v[234:235], v20 offset:41472
    ds_read_b64_tr_b16 v[236:237], v0 offset:61440
    ds_read_b64_tr_b16 v[238:239], v0 offset:61952
    s_waitcnt lgkmcnt(12)
    v_mfma_f32_16x16x32_bf16 v[12:15], v[16:19], v[212:215], v[12:15]
    ds_read_b64_tr_b16 v[240:241], v20 offset:0
    ds_read_b64_tr_b16 v[242:243], v20 offset:512
    s_waitcnt lgkmcnt(12)
    v_mfma_f32_16x16x32_bf16 v[12:15], v[16:19], v[216:219], v[12:15]
    ds_read_b64_tr_b16 v[244:245], v20 offset:4096
    ds_read_b64_tr_b16 v[246:247], v20 offset:4608
    s_waitcnt lgkmcnt(12)
    v_mfma_f32_16x16x32_bf16 v[12:15], v[16:19], v[220:223], v[12:15]
    ds_read_b64_tr_b16 v[248:249], v20 offset:8192
    ds_read_b64_tr_b16 v[250:251], v20 offset:8704
    s_waitcnt lgkmcnt(12)
    v_mfma_f32_16x16x32_bf16 v[12:15], v[16:19], v[224:227], v[12:15]
    ds_read_b64_tr_b16 v[252:253], v20 offset:12288
    ds_read_b64_tr_b16 v[254:255], v20 offset:12800
    s_waitcnt lgkmcnt(12)
    v_mfma_f32_16x16x32_bf16 v[12:15], v[16:19], v[228:231], v[12:15]
    s_waitcnt lgkmcnt(10)
    v_mfma_f32_16x16x32_bf16 v[12:15], v[16:19], v[232:235], v[12:15]
    s_waitcnt lgkmcnt(8)
    v_mfma_f32_16x16x32_bf16 v[12:15], v[16:19], v[236:239], v[12:15]
    s_waitcnt lgkmcnt(6)
    v_mfma_f32_16x16x32_bf16 v[12:15], v[16:19], v[240:243], v[12:15]
    s_waitcnt lgkmcnt(4)
    v_mfma_f32_16x16x32_bf16 v[12:15], v[16:19], v[244:247], v[12:15]
    s_waitcnt lgkmcnt(2)
    v_mfma_f32_16x16x32_bf16 v[12:15], v[16:19], v[248:251], v[12:15]
    s_waitcnt lgkmcnt(0)
    v_mfma_f32_16x16x32_bf16 v[12:15], v[16:19], v[252:255], v[12:15]
    v_cmp_gt_u32 vcc, 2, v2
    v_mul_u32_u24 v34, 3456, v2
    s_setprio 2
    s_nop 2
    v_cndmask_b32_e64 v34, v9, v34, vcc
    v_cmp_gt_u32 vcc, 32, v2
    s_nop 1
    v_cvt_pk_bf16_f32 v35, v12, v12
    v_and_b32 v35, 0xffff0000, v35
    v_sub_f32_e64 v35, v12, v35
    v_cvt_pk_bf16_f32 v35, v12, v35
    v_mov_b32 v12, v34
    v_cndmask_b32 v60, 0, v35, vcc
    s_waitcnt vmcnt(5)
    s_barrier
    ds_read_b64_tr_b16 v[28:29], v4 offset:0
    ds_read_b64_tr_b16 v[30:31], v4 offset:256
    ds_read_b64_tr_b16 v[32:33], v4 offset:1024
    ds_read_b64_tr_b16 v[34:35], v4 offset:1280
    ds_read_b64_tr_b16 v[36:37], v4 offset:2048
    ds_read_b64_tr_b16 v[38:39], v4 offset:2304
    ds_read_b64_tr_b16 v[40:41], v4 offset:3072
    ds_read_b64_tr_b16 v[42:43], v4 offset:3328
    ds_read_b64_tr_b16 v[44:45], v4 offset:4096
    ds_read_b64_tr_b16 v[46:47], v4 offset:4352
    ds_read_b64_tr_b16 v[48:49], v4 offset:5120
    ds_read_b64_tr_b16 v[50:51], v4 offset:5376
    ds_read_b64_tr_b16 v[52:53], v4 offset:6144
    ds_read_b64_tr_b16 v[54:55], v4 offset:6400
    ds_read_b64_tr_b16 v[56:57], v4 offset:7168
    ds_read_b64_tr_b16 v[58:59], v4 offset:7424
    .p2align 4
L_loop55:
    s_waitcnt lgkmcnt(8)
    v_mfma_f32_32x32x16_bf16 v[64:79], v[96:99], v[28:31], 0
    ds_read_b64_tr_b16 v[28:29], v4 offset:8192
    ds_read_b64_tr_b16 v[30:31], v4 offset:8448
    v_mfma_f32_32x32x16_bf16 v[64:79], v[100:103], v[32:35], v[64:79]
    ds_read_b64_tr_b16 v[32:33], v4 offset:9216
    ds_read_b64_tr_b16 v[34:35], v4 offset:9472
    v_mfma_f32_32x32x16_bf16 v[64:79], v[104:107], v[36:39], v[64:79]
    ds_read_b64_tr_b16 v[36:37], v4 offset:10240
    ds_read_b64_tr_b16 v[38:39], v4 offset:10496
    v_mfma_f32_32x32x16_bf16 v[64:79], v[108:111], v[40:43], v[64:79]
    ds_read_b64_tr_b16 v[40:41], v4 offset:11264
    ds_read_b64_tr_b16 v[42:43], v4 offset:11520
    s_waitcnt lgkmcnt(8)
    v_mfma_f32_32x32x16_bf16 v[64:79], v[112:115], v[44:47], v[64:79]
    ds_read_b64_tr_b16 v[44:45], v4 offset:12288
    ds_read_b64_tr_b16 v[46:47], v4 offset:12544
    v_mfma_f32_32x32x16_bf16 v[64:79], v[116:119], v[48:51], v[64:79]
    ds_read_b64_tr_b16 v[48:49], v4 offset:13312
    ds_read_b64_tr_b16 v[50:51], v4 offset:13568
    v_mfma_f32_32x32x16_bf16 v[64:79], v[120:123], v[52:55], v[64:79]
    ds_read_b64_tr_b16 v[52:53], v4 offset:14336
    ds_read_b64_tr_b16 v[54:55], v4 offset:14592
    v_mfma_f32_32x32x16_bf16 v[64:79], v[124:127], v[56:59], v[64:79]
    ds_read_b64_tr_b16 v[56:57], v4 offset:15360
    ds_read_b64_tr_b16 v[58:59], v4 offset:15616
    s_waitcnt lgkmcnt(8)
    v_mfma_f32_32x32x16_bf16 v[64:79], v[128:131], v[28:31], v[64:79]
    ds_read_b64_tr_b16 v[28:29], v4 offset:16384
    ds_read_b64_tr_b16 v[30:31], v4 offset:16640
    v_mfma_f32_32x32x16_bf16 v[64:79], v[132:135], v[32:35], v[64:79]
    ds_read_b64_tr_b16 v[32:33], v4 offset:17408
    ds_read_b64_tr_b16 v[34:35], v4 offset:17664
    v_mfma_f32_32x32x16_bf16 v[64:79], v[136:139], v[36:39], v[64:79]
    ds_read_b64_tr_b16 v[36:37], v4 offset:18432
    ds_read_b64_tr_b16 v[38:39], v4 offset:18688
    v_mfma_f32_32x32x16_bf16 v[64:79], v[140:143], v[40:43], v[64:79]
    s_cmp_lg_u32 s37, 0
    s_cbranch_scc1 L_c156
    s_waitcnt vmcnt(0)
L_c156:
    ds_read_b64_tr_b16 v[40:41], v4 offset:19456
    ds_read_b64_tr_b16 v[42:43], v4 offset:19712
    s_waitcnt lgkmcnt(8)
    v_mfma_f32_32x32x16_bf16 v[64:79], v[144:147], v[44:47], v[64:79]
    s_barrier
    ds_read_b64_tr_b16 v[44:45], v4 offset:20480
    ds_read_b64_tr_b16 v[46:47], v4 offset:20736
    ds_read_b96 v[24:26], v6 offset:0
    v_mfma_f32_32x32x16_bf16 v[64:79], v[148:151], v[48:51], v[64:79]
    ds_read_b64_tr_b16 v[48:49], v4 offset:21504
    ds_read_b64_tr_b16 v[50:51], v4 offset:21760
    v_mfma_f32_32x32x16_bf16 v[64:79], v[152:155], v[52:55], v[64:79]
    ds_read_b64_tr_b16 v[52:53], v4 offset:22528
    ds_read_b64_tr_b16 v[54:55], v4 offset:22784
    v_mfma_f32_32x32x16_bf16 v[64:79], v[156:159], v[56:59], v[64:79]
    ds_read_b64_tr_b16 v[56:57], v4 offset:23552
    ds_read_b64_tr_b16 v[58:59], v4 offset:23808
    s_waitcnt lgkmcnt(6)
    v_mfma_f32_32x32x16_bf16 v[80:95], v[60:63], v[24:27], v[80:95]
    v_mfma_f32_32x32x16_bf16 v[64:79], v[160:163], v[28:31], v[64:79]
    ds_read_b64_tr_b16 v[28:29], v4 offset:24576
    ds_read_b64_tr_b16 v[30:31], v4 offset:24832
    v_mfma_f32_32x32x16_bf16 v[64:79], v[164:167], v[32:35], v[64:79]
    ds_read_b64_tr_b16 v[32:33], v4 offset:25600
    ds_read_b64_tr_b16 v[34:35], v4 offset:25856
    v_mul_f32 v18, v80, v25
    v_mul_f32 v19, v81, v25
    v_exp_f32 v18, v18
    v_mfma_f32_32x32x16_bf16 v[64:79], v[168:171], v[36:39], v[64:79]
    ds_read_b64_tr_b16 v[36:37], v4 offset:26624
    ds_read_b64_tr_b16 v[38:39], v4 offset:26880
    v_mul_f32 v80, v80, v84
    v_exp_f32 v19, v19
    v_mul_f32_e64 v81, v81, v85
    v_mfma_f32_32x32x16_bf16 v[64:79], v[172:175], v[40:43], v[64:79]
    ds_read_b64_tr_b16 v[40:41], v4 offset:27648
    ds_read_b64_tr_b16 v[42:43], v4 offset:27904
    v_fma_f32 v18, v18, v26, v26
    v_fma_f32 v19, v19, v26, v26
    v_rcp_f32 v18, v18
    s_waitcnt lgkmcnt(8)
    v_mfma_f32_32x32x16_bf16 v[64:79], v[176:179], v[44:47], v[64:79]
    ds_read_b64_tr_b16 v[44:45], v4 offset:28672
    ds_read_b64_tr_b16 v[46:47], v4 offset:28928
    v_rcp_f32 v19, v19
    v_mul_f32 v80, v80, v18
    v_mfma_f32_32x32x16_bf16 v[64:79], v[180:183], v[48:51], v[64:79]
    ds_read_b64_tr_b16 v[48:49], v4 offset:29696
    ds_read_b64_tr_b16 v[50:51], v4 offset:29952
    v_mul_f32_e64 v81, v81, v19
    v_cvt_pk_bf16_f32 v20, v80, v81
    v_mul_f32 v18, v82, v25
    v_mul_f32 v19, v83, v25
    v_mfma_f32_32x32x16_bf16 v[64:79], v[184:187], v[52:55], v[64:79]
    ds_read_b64_tr_b16 v[52:53], v4 offset:30720
    ds_read_b64_tr_b16 v[54:55], v4 offset:30976
    v_exp_f32 v18, v18
    v_mul_f32 v82, v82, v86
    v_mfma_f32_32x32x16_bf16 v[64:79], v[188:191], v[56:59], v[64:79]
    ds_read_b64_tr_b16 v[56:57], v4 offset:31744
    ds_read_b64_tr_b16 v[58:59], v4 offset:32000
    v_exp_f32 v19, v19
    v_mul_f32 v83, v83, v87
    v_fma_f32 v18, v18, v26, v26
    s_waitcnt lgkmcnt(8)
    v_mfma_f32_32x32x16_bf16 v[64:79], v[192:195], v[28:31], v[64:79]
    ds_read_b64_tr_b16 v[28:29], v4 offset:32768
    ds_read_b64_tr_b16 v[30:31], v4 offset:33024
    v_fma_f32 v19, v19, v26, v26
    v_rcp_f32 v18, v18
    v_mfma_f32_32x32x16_bf16 v[64:79], v[196:199], v[32:35], v[64:79]
    ds_read_b64_tr_b16 v[32:33], v4 offset:33792
    ds_read_b64_tr_b16 v[34:35], v4 offset:34048
    v_rcp_f32 v19, v19
    v_mul_f32 v82, v82, v18
    v_mul_f32_e64 v83, v83, v19
    v_mfma_f32_32x32x16_bf16 v[64:79], v[200:203], v[36:39], v[64:79]
    ds_read_b64_tr_b16 v[36:37], v4 offset:34816
    ds_read_b64_tr_b16 v[38:39], v4 offset:35072
    v_cvt_pk_bf16_f32 v21, v82, v83
    v_mul_f32 v18, v88, v25
    v_mul_f32 v19, v89, v25
    v_mfma_f32_32x32x16_bf16 v[64:79], v[204:207], v[40:43], v[64:79]
    ds_read_b64_tr_b16 v[40:41], v4 offset:35840
    ds_read_b64_tr_b16 v[42:43], v4 offset:36096
    v_exp_f32_e64 v18, v18
    v_mul_f32 v88, v88, v92
    s_waitcnt lgkmcnt(8)
    v_mfma_f32_32x32x16_bf16 v[64:79], v[208:211], v[44:47], v[64:79]
    ds_read_b64_tr_b16 v[44:45], v4 offset:36864
    ds_read_b64_tr_b16 v[46:47], v4 offset:37120
    v_exp_f32 v19, v19
    v_mul_f32 v89, v89, v93
    v_mfma_f32_32x32x16_bf16 v[64:79], v[212:215], v[48:51], v[64:79]
    ds_read_b64_tr_b16 v[48:49], v4 offset:37888
    ds_read_b64_tr_b16 v[50:51], v4 offset:38144
    v_fma_f32 v18, v18, v26, v26
    v_fma_f32 v19, v19, v26, v26
    v_rcp_f32_e64 v18, v18
    v_mfma_f32_32x32x16_bf16 v[64:79], v[216:219], v[52:55], v[64:79]
    ds_read_b64_tr_b16 v[52:53], v4 offset:38912
    ds_read_b64_tr_b16 v[54:55], v4 offset:39168
    v_rcp_f32 v19, v19
    v_mul_f32 v88, v88, v18
    v_mul_f32_e64 v89, v89, v19
    v_mfma_f32_32x32x16_bf16 v[64:79], v[220:223], v[56:59], v[64:79]
    ds_read_b64_tr_b16 v[56:57], v4 offset:39936
    ds_read_b64_tr_b16 v[58:59], v4 offset:40192
    v_cvt_pk_bf16_f32 v22, v88, v89
    v_mul_f32_e64 v18, v90, v25
    v_mul_f32 v19, v91, v25
    s_waitcnt lgkmcnt(8)
    v_mfma_f32_32x32x16_bf16 v[64:79], v[224:227], v[28:31], v[64:79]
    s_barrier
    ds_read_b64_tr_b16 v[28:29], v5 offset:0
    ds_read_b64_tr_b16 v[30:31], v5 offset:256
    v_mfma_f32_32x32x16_bf16 v[64:79], v[228:231], v[32:35], v[64:79]
    ds_read_b64_tr_b16 v[32:33], v5 offset:1024
    ds_read_b64_tr_b16 v[34:35], v5 offset:1280
    v_exp_f32 v18, v18
    v_mul_f32_e64 v90, v90, v94
    v_mfma_f32_32x32x16_bf16 v[64:79], v[232:235], v[36:39], v[64:79]
    ds_read_b64_tr_b16 v[36:37], v5 offset:2048
    ds_read_b64_tr_b16 v[38:39], v5 offset:2304
    v_exp_f32 v19, v19
    v_mul_f32 v91, v91, v95
    v_fma_f32 v18, v18, v26, v26
    v_mfma_f32_32x32x16_bf16 v[64:79], v[236:239], v[40:43], v[64:79]
    ds_read_b64_tr_b16 v[40:41], v5 offset:3072
    ds_read_b64_tr_b16 v[42:43], v5 offset:3328
    v_fma_f32 v19, v19, v26, v26
    v_rcp_f32 v18, v18
    s_waitcnt lgkmcnt(8)
    v_mfma_f32_32x32x16_bf16 v[64:79], v[240:243], v[44:47], v[64:79]
    ds_read_b64_tr_b16 v[44:45], v5 offset:4096
    ds_read_b64_tr_b16 v[46:47], v5 offset:4352
    v_rcp_f32 v19, v19
    v_mul_f32 v90, v90, v18
    v_mfma_f32_32x32x16_bf16 v[64:79], v[244:247], v[48:51], v[64:79]
    ds_read_b64_tr_b16 v[48:49], v5 offset:5120
    ds_read_b64_tr_b16 v[50:51], v5 offset:5376
    v_mul_f32_e64 v91, v91, v19
    v_cvt_pk_bf16_f32 v23, v90, v91
    s_waitcnt vmcnt(0)
    buffer_store_dword v11, v9, s[48:51], s29 offen offset:0 sc1
    v_mfma_f32_32x32x16_bf16 v[64:79], v[248:251], v[52:55], v[64:79]
    ds_read_b64_tr_b16 v[52:53], v5 offset:6144
    ds_read_b64_tr_b16 v[54:55], v5 offset:6400
    buffer_store_dwordx4 v[20:23], v7, s[40:43], s36 offen sc1
    v_mov_b32 v7, v8
    s_add_u32 s36, s36, s39
    v_mfma_f32_32x32x16_bf16 v[64:79], v[252:255], v[56:59], v[64:79]
    ds_read_b64_tr_b16 v[56:57], v5 offset:7168
    ds_read_b64_tr_b16 v[58:59], v5 offset:7424
    s_waitcnt lgkmcnt(8)
    v_mfma_f32_32x32x16_bf16 v[80:95], v[96:99], v[28:31], 0
    ds_read_b64_tr_b16 v[28:29], v5 offset:8192
    ds_read_b64_tr_b16 v[30:31], v5 offset:8448
    v_mfma_f32_32x32x16_bf16 v[80:95], v[100:103], v[32:35], v[80:95]
    ds_read_b64_tr_b16 v[32:33], v5 offset:9216
    ds_read_b64_tr_b16 v[34:35], v5 offset:9472
    v_mfma_f32_32x32x16_bf16 v[80:95], v[104:107], v[36:39], v[80:95]
    ds_read_b64_tr_b16 v[36:37], v5 offset:10240
    ds_read_b64_tr_b16 v[38:39], v5 offset:10496
    v_mfma_f32_32x32x16_bf16 v[80:95], v[108:111], v[40:43], v[80:95]
    ds_read_b64_tr_b16 v[40:41], v5 offset:11264
    ds_read_b64_tr_b16 v[42:43], v5 offset:11520
    s_waitcnt lgkmcnt(8)
    v_mfma_f32_32x32x16_bf16 v[80:95], v[112:115], v[44:47], v[80:95]
    ds_read_b64_tr_b16 v[44:45], v5 offset:12288
    ds_read_b64_tr_b16 v[46:47], v5 offset:12544
    v_mfma_f32_32x32x16_bf16 v[80:95], v[116:119], v[48:51], v[80:95]
    ds_read_b64_tr_b16 v[48:49], v5 offset:13312
    ds_read_b64_tr_b16 v[50:51], v5 offset:13568
    v_mfma_f32_32x32x16_bf16 v[80:95], v[120:123], v[52:55], v[80:95]
    ds_read_b64_tr_b16 v[52:53], v5 offset:14336
    ds_read_b64_tr_b16 v[54:55], v5 offset:14592
    v_mfma_f32_32x32x16_bf16 v[80:95], v[124:127], v[56:59], v[80:95]
    ds_read_b64_tr_b16 v[56:57], v5 offset:15360
    ds_read_b64_tr_b16 v[58:59], v5 offset:15616
    s_waitcnt lgkmcnt(8)
    v_mfma_f32_32x32x16_bf16 v[80:95], v[128:131], v[28:31], v[80:95]
    ds_read_b64_tr_b16 v[28:29], v5 offset:16384
    ds_read_b64_tr_b16 v[30:31], v5 offset:16640
    v_mfma_f32_32x32x16_bf16 v[80:95], v[132:135], v[32:35], v[80:95]
    ds_read_b64_tr_b16 v[32:33], v5 offset:17408
    ds_read_b64_tr_b16 v[34:35], v5 offset:17664
    v_mfma_f32_32x32x16_bf16 v[80:95], v[136:139], v[36:39], v[80:95]
    ds_read_b64_tr_b16 v[36:37], v5 offset:18432
    ds_read_b64_tr_b16 v[38:39], v5 offset:18688
    v_mfma_f32_32x32x16_bf16 v[80:95], v[140:143], v[40:43], v[80:95]
    ds_read_b64_tr_b16 v[40:41], v5 offset:19456
    ds_read_b64_tr_b16 v[42:43], v5 offset:19712
    s_waitcnt lgkmcnt(8)
    v_mfma_f32_32x32x16_bf16 v[80:95], v[144:147], v[44:47], v[80:95]
    s_barrier
    ds_read_b64_tr_b16 v[44:45], v5 offset:20480
    ds_read_b64_tr_b16 v[46:47], v5 offset:20736
    ds_read_b96 v[24:26], v6 offset:512
    v_mfma_f32_32x32x16_bf16 v[80:95], v[148:151], v[48:51], v[80:95]
    ds_read_b64_tr_b16 v[48:49], v5 offset:21504
    ds_read_b64_tr_b16 v[50:51], v5 offset:21760
    v_mfma_f32_32x32x16_bf16 v[80:95], v[152:155], v[52:55], v[80:95]
    ds_read_b64_tr_b16 v[52:53], v5 offset:22528
    ds_read_b64_tr_b16 v[54:55], v5 offset:22784
    v_mfma_f32_32x32x16_bf16 v[80:95], v[156:159], v[56:59], v[80:95]
    ds_read_b64_tr_b16 v[56:57], v5 offset:23552
    ds_read_b64_tr_b16 v[58:59], v5 offset:23808
    s_waitcnt lgkmcnt(6)
    v_mfma_f32_32x32x16_bf16 v[64:79], v[60:63], v[24:27], v[64:79]
    v_mfma_f32_32x32x16_bf16 v[80:95], v[160:163], v[28:31], v[80:95]
    ds_read_b64_tr_b16 v[28:29], v5 offset:24576
    ds_read_b64_tr_b16 v[30:31], v5 offset:24832
    v_mfma_f32_32x32x16_bf16 v[80:95], v[164:167], v[32:35], v[80:95]
    ds_read_b64_tr_b16 v[32:33], v5 offset:25600
    ds_read_b64_tr_b16 v[34:35], v5 offset:25856
    v_mul_f32 v18, v64, v25
    v_mul_f32 v19, v65, v25
    v_exp_f32 v18, v18
    v_mfma_f32_32x32x16_bf16 v[80:95], v[168:171], v[36:39], v[80:95]
    ds_read_b64_tr_b16 v[36:37], v5 offset:26624
    ds_read_b64_tr_b16 v[38:39], v5 offset:26880
    v_mul_f32 v64, v64, v68
    v_exp_f32 v19, v19
    v_mul_f32_e64 v65, v65, v69
    v_mfma_f32_32x32x16_bf16 v[80:95], v[172:175], v[40:43], v[80:95]
    ds_read_b64_tr_b16 v[40:41], v5 offset:27648
    ds_read_b64_tr_b16 v[42:43], v5 offset:27904
    v_fma_f32 v18, v18, v26, v26
    v_fma_f32 v19, v19, v26, v26
    v_rcp_f32 v18, v18
    s_waitcnt lgkmcnt(8)
    v_mfma_f32_32x32x16_bf16 v[80:95], v[176:179], v[44:47], v[80:95]
    ds_read_b64_tr_b16 v[44:45], v5 offset:28672
    ds_read_b64_tr_b16 v[46:47], v5 offset:28928
    v_rcp_f32 v19, v19
    v_mul_f32 v64, v64, v18
    v_mfma_f32_32x32x16_bf16 v[80:95], v[180:183], v[48:51], v[80:95]
    ds_read_b64_tr_b16 v[48:49], v5 offset:29696
    ds_read_b64_tr_b16 v[50:51], v5 offset:29952
    v_mul_f32_e64 v65, v65, v19
    v_cvt_pk_bf16_f32 v20, v64, v65
    v_mul_f32 v18, v66, v25
    v_mul_f32 v19, v67, v25
    v_mfma_f32_32x32x16_bf16 v[80:95], v[184:187], v[52:55], v[80:95]
    ds_read_b64_tr_b16 v[52:53], v5 offset:30720
    ds_read_b64_tr_b16 v[54:55], v5 offset:30976
    v_exp_f32 v18, v18
    v_mul_f32 v66, v66, v70
    v_mfma_f32_32x32x16_bf16 v[80:95], v[188:191], v[56:59], v[80:95]
    ds_read_b64_tr_b16 v[56:57], v5 offset:31744
    ds_read_b64_tr_b16 v[58:59], v5 offset:32000
    v_exp_f32 v19, v19
    v_mul_f32 v67, v67, v71
    v_fma_f32 v18, v18, v26, v26
    s_waitcnt lgkmcnt(8)
    v_mfma_f32_32x32x16_bf16 v[80:95], v[192:195], v[28:31], v[80:95]
    ds_read_b64_tr_b16 v[28:29], v5 offset:32768
    ds_read_b64_tr_b16 v[30:31], v5 offset:33024
    v_fma_f32 v19, v19, v26, v26
    v_rcp_f32 v18, v18
    v_mfma_f32_32x32x16_bf16 v[80:95], v[196:199], v[32:35], v[80:95]
    ds_read_b64_tr_b16 v[32:33], v5 offset:33792
    ds_read_b64_tr_b16 v[34:35], v5 offset:34048
    v_rcp_f32 v19, v19
    v_mul_f32 v66, v66, v18
    v_mul_f32_e64 v67, v67, v19
    v_mfma_f32_32x32x16_bf16 v[80:95], v[200:203], v[36:39], v[80:95]
    ds_read_b64_tr_b16 v[36:37], v5 offset:34816
    ds_read_b64_tr_b16 v[38:39], v5 offset:35072
    v_cvt_pk_bf16_f32 v21, v66, v67
    v_mul_f32 v18, v72, v25
    v_mul_f32 v19, v73, v25
    v_mfma_f32_32x32x16_bf16 v[80:95], v[204:207], v[40:43], v[80:95]
    ds_read_b64_tr_b16 v[40:41], v5 offset:35840
    ds_read_b64_tr_b16 v[42:43], v5 offset:36096
    v_exp_f32_e64 v18, v18
    v_mul_f32 v72, v72, v76
    s_waitcnt lgkmcnt(8)
    v_mfma_f32_32x32x16_bf16 v[80:95], v[208:211], v[44:47], v[80:95]
    ds_read_b64_tr_b16 v[44:45], v5 offset:36864
    ds_read_b64_tr_b16 v[46:47], v5 offset:37120
    v_exp_f32 v19, v19
    v_mul_f32 v73, v73, v77
    v_mfma_f32_32x32x16_bf16 v[80:95], v[212:215], v[48:51], v[80:95]
    ds_read_b64_tr_b16 v[48:49], v5 offset:37888
    ds_read_b64_tr_b16 v[50:51], v5 offset:38144
    v_fma_f32 v18, v18, v26, v26
    v_fma_f32 v19, v19, v26, v26
    v_rcp_f32_e64 v18, v18
    v_mfma_f32_32x32x16_bf16 v[80:95], v[216:219], v[52:55], v[80:95]
    ds_read_b64_tr_b16 v[52:53], v5 offset:38912
    ds_read_b64_tr_b16 v[54:55], v5 offset:39168
    v_rcp_f32 v19, v19
    v_mul_f32 v72, v72, v18
    v_mul_f32_e64 v73, v73, v19
    v_mfma_f32_32x32x16_bf16 v[80:95], v[220:223], v[56:59], v[80:95]
    ds_read_b64_tr_b16 v[56:57], v5 offset:39936
    ds_read_b64_tr_b16 v[58:59], v5 offset:40192
    v_cvt_pk_bf16_f32 v22, v72, v73
    v_mul_f32_e64 v18, v74, v25
    v_mul_f32 v19, v75, v25
    s_waitcnt lgkmcnt(8)
    v_mfma_f32_32x32x16_bf16 v[80:95], v[224:227], v[28:31], v[80:95]
    s_barrier
    ds_read_b64_tr_b16 v[28:29], v4 offset:0
    ds_read_b64_tr_b16 v[30:31], v4 offset:256
    v_mfma_f32_32x32x16_bf16 v[80:95], v[228:231], v[32:35], v[80:95]
    ds_read_b64_tr_b16 v[32:33], v4 offset:1024
    ds_read_b64_tr_b16 v[34:35], v4 offset:1280
    v_exp_f32 v18, v18
    v_mul_f32_e64 v74, v74, v78
    v_mfma_f32_32x32x16_bf16 v[80:95], v[232:235], v[36:39], v[80:95]
    ds_read_b64_tr_b16 v[36:37], v4 offset:2048
    ds_read_b64_tr_b16 v[38:39], v4 offset:2304
    v_exp_f32 v19, v19
    v_mul_f32 v75, v75, v79
    v_fma_f32 v18, v18, v26, v26
    v_mfma_f32_32x32x16_bf16 v[80:95], v[236:239], v[40:43], v[80:95]
    ds_read_b64_tr_b16 v[40:41], v4 offset:3072
    ds_read_b64_tr_b16 v[42:43], v4 offset:3328
    v_fma_f32 v19, v19, v26, v26
    v_rcp_f32 v18, v18
    s_waitcnt lgkmcnt(8)
    v_mfma_f32_32x32x16_bf16 v[80:95], v[240:243], v[44:47], v[80:95]
    ds_read_b64_tr_b16 v[44:45], v4 offset:4096
    ds_read_b64_tr_b16 v[46:47], v4 offset:4352
    v_rcp_f32 v19, v19
    v_mul_f32 v74, v74, v18
    v_mfma_f32_32x32x16_bf16 v[80:95], v[244:247], v[48:51], v[80:95]
    ds_read_b64_tr_b16 v[48:49], v4 offset:5120
    ds_read_b64_tr_b16 v[50:51], v4 offset:5376
    v_mul_f32_e64 v75, v75, v19
    v_cvt_pk_bf16_f32 v23, v74, v75
    s_waitcnt vmcnt(0)
    buffer_store_dword v11, v9, s[48:51], s29 offen offset:3456 sc1
    v_mfma_f32_32x32x16_bf16 v[80:95], v[248:251], v[52:55], v[80:95]
    ds_read_b64_tr_b16 v[52:53], v4 offset:6144
    ds_read_b64_tr_b16 v[54:55], v4 offset:6400
    buffer_store_dwordx4 v[20:23], v7, s[40:43], s36 offen sc1
    v_add_u32 v6, 1024, v6
    v_mov_b32 v9, v10
    s_add_u32 s29, s29, 6912
    v_mfma_f32_32x32x16_bf16 v[80:95], v[252:255], v[56:59], v[80:95]
    ds_read_b64_tr_b16 v[56:57], v4 offset:7168
    ds_read_b64_tr_b16 v[58:59], v4 offset:7424
    s_add_u32 s36, s36, 110592
    s_mov_b32 s39, 110592
    s_add_u32 s37, s37, 1
    s_cmp_lt_u32 s37, 4
    s_cbranch_scc1 L_loop55
    ds_read_b96 v[24:26], v6
    v_lshlrev_b32 v13, 4, v2
    s_mul_i32 s35, s30, 5
    s_cmp_eq_u32 s30, 3
    s_cselect_b32 s35, 13, s35
    s_mul_i32 s33, s35, 5120
    s_add_u32 s33, s33, 86016
    v_add_u32 v244, s33, v13
    s_add_u32 s33, s33, 10240
    s_cmp_eq_u32 s30, 3
    s_cselect_b32 s33, 0, s33
    v_add_u32 v245, s33, v13
    s_add_u32 s35, s35, 36
    s_lshl_b32 s83, s35, 10
    s_add_u32 s80, s72, s83
    s_add_u32 s81, s80, 4096
    s_cmp_eq_u32 s30, 3
    s_cselect_b32 s35, 0x7ff00000, 0
    v_or_b32 v246, s35, v13
    s_cmp_eq_u32 s30, 2
    s_cselect_b32 s35, 0x7ff00000, 0
    v_or_b32 v247, s35, v13
    s_waitcnt lgkmcnt(0)
    v_mfma_f32_32x32x16_bf16 v[80:95], v[60:63], v[24:27], v[80:95]
    buffer_load_dwordx4 v[196:199], v246, s[40:43], s80 offen offset:0 sc1
    buffer_load_dwordx4 v[200:203], v13, s[40:43], s80 offen offset:1024 sc1
    buffer_load_dwordx4 v[204:207], v13, s[40:43], s80 offen offset:2048 sc1
    buffer_load_dwordx4 v[208:211], v13, s[40:43], s80 offen offset:3072 sc1
    buffer_load_dwordx4 v[212:215], v247, s[40:43], s81 offen offset:0 sc1
    ds_read_b128 v[96:99], v244 offset:0
    ds_read_b128 v[100:103], v244 offset:1024
    ds_read_b128 v[104:107], v244 offset:2048
    ds_read_b128 v[108:111], v244 offset:3072
    ds_read_b128 v[112:115], v244 offset:4096
    s_nop 2
    v_mul_f32 v18, v80, v25
    v_mul_f32 v19, v81, v25
    ds_read_b128 v[116:119], v244 offset:5120
    v_exp_f32 v18, v18
    v_mul_f32 v80, v80, v84
    v_exp_f32 v19, v19
    v_mul_f32 v81, v81, v85
    ds_read_b128 v[120:123], v244 offset:6144
    v_fma_f32 v18, v18, v26, v26
    v_fma_f32 v19, v19, v26, v26
    v_rcp_f32 v18, v18
    v_rcp_f32 v19, v19
    ds_read_b128 v[124:127], v244 offset:7168
    v_mul_f32 v80, v80, v18
    v_mul_f32 v81, v81, v19
    v_cvt_pk_bf16_f32 v20, v80, v81
    v_mul_f32_e64 v18, v82, v25
    ds_read_b128 v[128:131], v244 offset:8192
    v_mul_f32 v19, v83, v25
    v_exp_f32 v18, v18
    v_mul_f32 v82, v82, v86
    v_exp_f32 v19, v19
    ds_read_b128 v[132:135], v244 offset:9216
    v_mul_f32_e64 v83, v83, v87
    v_fma_f32 v18, v18, v26, v26
    v_fma_f32 v19, v19, v26, v26
    v_rcp_f32 v18, v18
    v_rcp_f32 v19, v19
    v_mul_f32 v82, v82, v18
    v_mul_f32 v83, v83, v19
    v_cvt_pk_bf16_f32 v21, v82, v83
    v_mul_f32 v18, v88, v25
    v_mul_f32 v19, v89, v25
    v_exp_f32 v18, v18
    v_mul_f32 v88, v88, v92
    v_exp_f32 v19, v19
    v_mul_f32 v89, v89, v93
    v_fma_f32 v18, v18, v26, v26
    v_fma_f32 v19, v19, v26, v26
    v_rcp_f32 v18, v18
    v_rcp_f32 v19, v19
    v_mul_f32 v88, v88, v18
    v_mul_f32 v89, v89, v19
    v_cvt_pk_bf16_f32 v22, v88, v89
    v_mul_f32 v18, v90, v25
    v_mul_f32 v19, v91, v25
    v_exp_f32 v18, v18
    v_mul_f32 v90, v90, v94
    v_exp_f32 v19, v19
    v_mul_f32 v91, v91, v95
    v_fma_f32 v18, v18, v26, v26
    v_fma_f32 v19, v19, v26, v26
    v_rcp_f32 v18, v18
    v_rcp_f32 v19, v19
    v_mul_f32 v90, v90, v18
    v_mul_f32 v91, v91, v19
    v_cvt_pk_bf16_f32 v23, v90, v91
    buffer_store_dwordx4 v[20:23], v7, s[40:43], s36 offen sc1
    s_setprio 2
L_g2w4:
    s_waitcnt vmcnt(5)
    s_waitcnt lgkmcnt(5)
    v_mfma_f32_16x16x32_bf16 v[216:219], v[96:99], v[196:199], 0
    s_add_u32 s80, s73, s83
    s_add_u32 s81, s80, 4096
    ds_read_b128 v[136:139], v245 offset:0
    ds_read_b128 v[140:143], v245 offset:1024
    ds_read_b128 v[144:147], v245 offset:2048
    v_mfma_f32_16x16x32_bf16 v[220:223], v[100:103], v[196:199], 0
    ds_read_b128 v[148:151], v245 offset:3072
    ds_read_b128 v[152:155], v245 offset:4096
    ds_read_b128 v[156:159], v245 offset:5120
    v_mfma_f32_16x16x32_bf16 v[224:227], v[104:107], v[196:199], 0
    ds_read_b128 v[160:163], v245 offset:6144
    ds_read_b128 v[164:167], v245 offset:7168
    ds_read_b128 v[168:171], v245 offset:8192
    v_mfma_f32_16x16x32_bf16 v[228:231], v[108:111], v[196:199], 0
    ds_read_b128 v[172:175], v245 offset:9216
    ds_read_b128 v[176:179], v245 offset:10240
    ds_read_b128 v[180:183], v245 offset:11264
    v_mfma_f32_16x16x32_bf16 v[232:235], v[112:115], v[196:199], 0
    ds_read_b128 v[184:187], v245 offset:12288
    ds_read_b128 v[188:191], v245 offset:13312
    ds_read_b128 v[192:195], v245 offset:14336
    buffer_load_dwordx4 v[196:199], v246, s[40:43], s80 offen offset:0 sc1
    s_waitcnt vmcnt(5)
    s_waitcnt lgkmcnt(15)
    v_mfma_f32_16x16x32_bf16 v[216:219], v[116:119], v[200:203], v[216:219]
    s_mul_i32 s35, s30, 5120
    v_add_u32_e64 v14, s35, v13
    v_add_u32 v15, 86016, v14
    v_mfma_f32_16x16x32_bf16 v[220:223], v[120:123], v[200:203], v[220:223]
    v_add_u32 v14, 40960, v14
    s_lshl_b32 s35, s30, 10
    v_add_u32 v16, s35, v13
    v_mfma_f32_16x16x32_bf16 v[224:227], v[124:127], v[200:203], v[224:227]
    v_add_u32 v17, 86016, v16
    v_add_u32 v16, 40960, v16
    s_lshl_b32 s35, s30, 9
    v_mfma_f32_16x16x32_bf16 v[228:231], v[128:131], v[200:203], v[228:231]
    s_add_u32 s35, s35, 20480
    v_lshlrev_b32 v3, 3, v2
    v_add_u32_e64 v3, s35, v3
    v_mfma_f32_16x16x32_bf16 v[232:235], v[132:135], v[200:203], v[232:235]
    v_and_b32_e64 v4, 7, v2
    v_bfe_u32 v236, v2, 3, 1
    v_lshl_add_u32 v4, v4, 2, v236
    buffer_load_dwordx4 v[200:203], v13, s[40:43], s80 offen offset:1024 sc1
    s_waitcnt vmcnt(5)
    s_waitcnt lgkmcnt(10)
    s_waitcnt vmcnt(2)
    buffer_store_dword v11, v12, s[48:51], s29 offen sc1
    v_mfma_f32_16x16x32_bf16 v[216:219], v[136:139], v[204:207], v[216:219]
    v_mul_u32_u24 v4, 1280, v4
    v_lshrrev_b32 v236, 4, v2
    v_lshl_add_u32 v4, v236, 3, v4
    v_mfma_f32_16x16x32_bf16 v[220:223], v[140:143], v[204:207], v[220:223]
    s_lshl_b32 s35, s30, 5
    v_add_u32 v4, s35, v4
    s_lshl_b32 s35, s30, 8
    v_mfma_f32_16x16x32_bf16 v[224:227], v[144:147], v[204:207], v[224:227]
    s_add_u32 s35, s35, 90112
    v_lshl_add_u32 v91, v2, 2, s35
    v_add_u32 v90, 4294922240, v91
    v_mfma_f32_16x16x32_bf16 v[228:231], v[148:151], v[204:207], v[228:231]
    s_lshl_b32 s35, s30, 7
    s_add_u32 s35, s35, 22528
    v_and_b32_e64 v236, 3, v2
    v_mfma_f32_16x16x32_bf16 v[232:235], v[152:155], v[204:207], v[232:235]
    v_lshl_add_u32 v92, v236, 5, s35
    v_lshrrev_b32_e64 v93, 2, v2
    v_lshl_add_u32 v92, v93, 1, v92
    buffer_load_dwordx4 v[204:207], v13, s[40:43], s80 offen offset:2048 sc1
    s_waitcnt lgkmcnt(5)
    v_mfma_f32_16x16x32_bf16 v[216:219], v[156:159], v[208:211], v[216:219]
    v_and_b32 v93, 28, v2
    v_lshrrev_b32 v236, 5, v2
    v_add_u32 v93, v93, v236
    v_mfma_f32_16x16x32_bf16 v[220:223], v[160:163], v[208:211], v[220:223]
    v_mul_u32_u24 v93, 1280, v93
    s_lshl_b32 s35, s30, 3
    s_add_u32 s35, s35, 128
    v_mfma_f32_16x16x32_bf16 v[224:227], v[164:167], v[208:211], v[224:227]
    v_and_b32 v236, 3, v2
    v_lshl_add_u32 v236, v236, 1, s35
    v_add_u32_e64 v93, v93, v236
    v_mfma_f32_16x16x32_bf16 v[228:231], v[168:171], v[208:211], v[228:231]
    v_mfma_f32_16x16x32_bf16 v[232:235], v[172:175], v[208:211], v[232:235]
    buffer_load_dwordx4 v[208:211], v13, s[40:43], s80 offen offset:3072 sc1
    s_waitcnt lgkmcnt(0)
    v_mfma_f32_16x16x32_bf16 v[216:219], v[176:179], v[212:215], v[216:219]
    v_mfma_f32_16x16x32_bf16 v[220:223], v[180:183], v[212:215], v[220:223]
    v_mfma_f32_16x16x32_bf16 v[224:227], v[184:187], v[212:215], v[224:227]
    v_mfma_f32_16x16x32_bf16 v[228:231], v[188:191], v[212:215], v[228:231]
    ds_write_b128 v14, v[216:219] offset:0
    v_mfma_f32_16x16x32_bf16 v[232:235], v[192:195], v[212:215], v[232:235]
    ds_write_b128 v14, v[220:223] offset:1024
    buffer_load_dwordx4 v[212:215], v247, s[40:43], s81 offen offset:0 sc1
    s_waitcnt vmcnt(5)
    v_mfma_f32_16x16x32_bf16 v[216:219], v[96:99], v[196:199], 0
    ds_write_b128 v14, v[224:227] offset:2048
    s_add_u32 s80, s74, s83
    s_add_u32 s81, s80, 4096
    v_mfma_f32_16x16x32_bf16 v[220:223], v[100:103], v[196:199], 0
    ds_write_b128 v14, v[228:231] offset:3072
    v_mfma_f32_16x16x32_bf16 v[224:227], v[104:107], v[196:199], 0
    ds_write_b128 v14, v[232:235] offset:4096
    v_mfma_f32_16x16x32_bf16 v[228:231], v[108:111], v[196:199], 0
    v_mfma_f32_16x16x32_bf16 v[232:235], v[112:115], v[196:199], 0
    v_mov_b32 v240, 16392
    s_mov_b32 s87, 0
L_sp57:
    ds_read_b32 v241, v240
    s_add_u32 s87, s87, 1
    s_waitcnt lgkmcnt(0)
    v_readfirstlane_b32 s86, v241
    s_cmp_ge_u32 s86, 1
    s_cbranch_scc1 L_sd58
    s_sleep 1
    s_cmp_lt_u32 s87, 200000
    s_cbranch_scc1 L_sp57
L_sd58:
    buffer_load_dwordx4 v[196:199], v246, s[40:43], s80 offen offset:0 sc1
    s_waitcnt vmcnt(5)
    v_mfma_f32_16x16x32_bf16 v[216:219], v[116:119], v[200:203], v[216:219]
    v_mfma_f32_16x16x32_bf16 v[220:223], v[120:123], v[200:203], v[220:223]
    v_mfma_f32_16x16x32_bf16 v[224:227], v[124:127], v[200:203], v[224:227]
    v_mfma_f32_16x16x32_bf16 v[228:231], v[128:131], v[200:203], v[228:231]
    v_mfma_f32_16x16x32_bf16 v[232:235], v[132:135], v[200:203], v[232:235]
    buffer_load_dwordx4 v[200:203], v13, s[40:43], s80 offen offset:1024 sc1
    s_waitcnt vmcnt(4)
    v_mfma_f32_16x16x32_bf16 v[216:219], v[136:139], v[204:207], v[216:219]
    v_mfma_f32_16x16x32_bf16 v[220:223], v[140:143], v[204:207], v[220:223]
    s_waitcnt lgkmcnt(0)
    s_barrier
    ds_read_b64_tr_b16 v[236:237], v3 offset:0
    ds_read_b128 v[28:31], v16 offset:0
    ds_read_b128 v[32:35], v16 offset:5120
    v_mfma_f32_16x16x32_bf16 v[224:227], v[144:147], v[204:207], v[224:227]
    ds_read_b128 v[36:39], v16 offset:10240
    ds_read_b128 v[40:43], v16 offset:15360
    ds_read_b128 v[44:47], v16 offset:20480
    v_mfma_f32_16x16x32_bf16 v[228:231], v[148:151], v[204:207], v[228:231]
    ds_read_b128 v[48:51], v16 offset:25600
    ds_read_b128 v[52:55], v16 offset:30720
    ds_read_b128 v[56:59], v16 offset:35840
    v_mfma_f32_16x16x32_bf16 v[232:235], v[152:155], v[204:207], v[232:235]
    ds_read_u16 v88, v92 offset:0
    ds_read2st64_b32 v[80:81], v90 offset0:0 offset1:20
    ds_read2st64_b32 v[82:83], v90 offset0:40 offset1:60
    buffer_load_dwordx4 v[204:207], v13, s[40:43], s80 offen offset:2048 sc1
    s_waitcnt vmcnt(4)
    v_mfma_f32_16x16x32_bf16 v[216:219], v[156:159], v[208:211], v[216:219]
    ds_read2st64_b32 v[84:85], v90 offset0:80 offset1:100
    ds_read2st64_b32 v[86:87], v90 offset0:120 offset1:140
    s_waitcnt lgkmcnt(13)
    v_mfma_f32_16x16x32_bf16 v[220:223], v[160:163], v[208:211], v[220:223]
    v_lshlrev_b32 v238, 16, v236
    v_and_b32 v239, 0xffff0000, v236
    v_lshlrev_b32_e64 v236, 16, v237
    v_mfma_f32_16x16x32_bf16 v[224:227], v[164:167], v[208:211], v[224:227]
    v_and_b32 v237, 0xffff0000, v237
    s_waitcnt lgkmcnt(11)
    v_pk_add_f32 v[28:29], v[28:29], v[32:33]
    v_mfma_f32_16x16x32_bf16 v[228:231], v[168:171], v[208:211], v[228:231]
    v_pk_add_f32 v[30:31], v[30:31], v[34:35]
    v_pk_add_f32 v[28:29], v[28:29], v[238:239]
    v_pk_add_f32 v[30:31], v[30:31], v[236:237]
    v_mfma_f32_16x16x32_bf16 v[232:235], v[172:175], v[208:211], v[232:235]
    s_waitcnt lgkmcnt(9)
    v_pk_add_f32 v[36:37], v[36:37], v[40:41]
    v_pk_add_f32 v[38:39], v[38:39], v[42:43]
    buffer_load_dwordx4 v[208:211], v13, s[40:43], s80 offen offset:3072 sc1
    s_waitcnt vmcnt(4)
    v_mfma_f32_16x16x32_bf16 v[216:219], v[176:179], v[212:215], v[216:219]
    v_pk_add_f32 v[28:29], v[28:29], v[36:37]
    v_pk_add_f32 v[30:31], v[30:31], v[38:39]
    s_waitcnt lgkmcnt(7)
    v_mfma_f32_16x16x32_bf16 v[220:223], v[180:183], v[212:215], v[220:223]
    v_pk_add_f32 v[44:45], v[44:45], v[48:49]
    v_pk_add_f32 v[46:47], v[46:47], v[50:51]
    v_pk_add_f32 v[28:29], v[28:29], v[44:45]
    v_mfma_f32_16x16x32_bf16 v[224:227], v[184:187], v[212:215], v[224:227]
    v_pk_add_f32 v[30:31], v[30:31], v[46:47]
    s_waitcnt lgkmcnt(5)
    v_pk_add_f32 v[52:53], v[52:53], v[56:57]
    v_mfma_f32_16x16x32_bf16 v[228:231], v[188:191], v[212:215], v[228:231]
    ds_write_b128 v15, v[216:219] offset:0
    v_pk_add_f32 v[54:55], v[54:55], v[58:59]
    v_pk_add_f32 v[28:29], v[28:29], v[52:53]
    v_pk_add_f32 v[30:31], v[30:31], v[54:55]
    v_mfma_f32_16x16x32_bf16 v[232:235], v[192:195], v[212:215], v[232:235]
    ds_write_b128 v15, v[220:223] offset:1024
    v_cvt_pk_bf16_f32 v236, v28, v29
    v_cvt_pk_bf16_f32 v237, v30, v31
    buffer_store_dwordx2 v[236:237], v4, s[52:55], s76 offen
    buffer_load_dwordx4 v[212:215], v247, s[40:43], s81 offen offset:0 sc1
    s_waitcnt vmcnt(5)
    v_mfma_f32_16x16x32_bf16 v[216:219], v[96:99], v[196:199], 0
    ds_write_b128 v15, v[224:227] offset:2048
    s_add_u32 s80, s75, s83
    s_add_u32 s81, s80, 4096
    s_waitcnt lgkmcnt(5)
    v_lshlrev_b32_e64 v88, 16, v88
    v_pk_add_f32 v[80:81], v[80:81], v[82:83]
    v_mfma_f32_16x16x32_bf16 v[220:223], v[100:103], v[196:199], 0
    ds_write_b128 v15, v[228:231] offset:3072
    s_waitcnt lgkmcnt(4)
    v_pk_add_f32 v[84:85], v[84:85], v[86:87]
    v_add_f32 v80, v80, v88
    v_mfma_f32_16x16x32_bf16 v[224:227], v[104:107], v[196:199], 0
    ds_write_b128 v15, v[232:235] offset:4096
    v_pk_add_f32 v[80:81], v[80:81], v[84:85]
    v_add_f32_e64 v80, v80, v81
    v_cvt_pk_bf16_f32 v80, v80, v80
    v_mfma_f32_16x16x32_bf16 v[228:231], v[108:111], v[196:199], 0
    buffer_store_short v80, v93, s[52:55], s76 offen
    v_mfma_f32_16x16x32_bf16 v[232:235], v[112:115], v[196:199], 0
    s_waitcnt lgkmcnt(0)
    s_barrier
    ds_read_b64_tr_b16 v[236:237], v3 offset:3072
    ds_read_b128 v[28:31], v17 offset:0
    ds_read_b128 v[32:35], v17 offset:5120
    s_waitcnt vmcnt(5)
    v_mfma_f32_16x16x32_bf16 v[216:219], v[116:119], v[200:203], v[216:219]
    ds_read_b128 v[36:39], v17 offset:10240
    ds_read_b128 v[40:43], v17 offset:15360
    ds_read_b128 v[44:47], v17 offset:20480
    v_mfma_f32_16x16x32_bf16 v[220:223], v[120:123], v[200:203], v[220:223]
    ds_read_b128 v[48:51], v17 offset:25600
    ds_read_b128 v[52:55], v17 offset:30720
    ds_read_b128 v[56:59], v17 offset:35840
    v_mfma_f32_16x16x32_bf16 v[224:227], v[124:127], v[200:203], v[224:227]
    ds_read_u16 v88, v92 offset:3072
    ds_read2st64_b32 v[80:81], v91 offset0:0 offset1:20
    ds_read2st64_b32 v[82:83], v91 offset0:40 offset1:60
    v_mfma_f32_16x16x32_bf16 v[228:231], v[128:131], v[200:203], v[228:231]
    ds_read2st64_b32 v[84:85], v91 offset0:80 offset1:100
    ds_read2st64_b32 v[86:87], v91 offset0:120 offset1:140
    s_waitcnt lgkmcnt(13)
    v_mfma_f32_16x16x32_bf16 v[232:235], v[132:135], v[200:203], v[232:235]
    v_lshlrev_b32_e64 v238, 16, v236
    v_and_b32 v239, 0xffff0000, v236
    v_lshlrev_b32 v236, 16, v237
    s_waitcnt vmcnt(4)
    v_mfma_f32_16x16x32_bf16 v[216:219], v[136:139], v[204:207], v[216:219]
    v_and_b32 v237, 0xffff0000, v237
    s_waitcnt lgkmcnt(11)
    v_pk_add_f32 v[28:29], v[28:29], v[32:33]
    v_mfma_f32_16x16x32_bf16 v[220:223], v[140:143], v[204:207], v[220:223]
    v_pk_add_f32 v[30:31], v[30:31], v[34:35]
    v_pk_add_f32 v[28:29], v[28:29], v[238:239]
    v_pk_add_f32 v[30:31], v[30:31], v[236:237]
    v_mfma_f32_16x16x32_bf16 v[224:227], v[144:147], v[204:207], v[224:227]
    s_waitcnt lgkmcnt(9)
    v_pk_add_f32 v[36:37], v[36:37], v[40:41]
    v_pk_add_f32 v[38:39], v[38:39], v[42:43]
    v_mfma_f32_16x16x32_bf16 v[228:231], v[148:151], v[204:207], v[228:231]
    v_pk_add_f32 v[28:29], v[28:29], v[36:37]
    v_pk_add_f32 v[30:31], v[30:31], v[38:39]
    s_waitcnt lgkmcnt(7)
    v_mfma_f32_16x16x32_bf16 v[232:235], v[152:155], v[204:207], v[232:235]
    v_pk_add_f32 v[44:45], v[44:45], v[48:49]
    v_pk_add_f32 v[46:47], v[46:47], v[50:51]
    v_pk_add_f32 v[28:29], v[28:29], v[44:45]
    v_mov_b32 v240, 16396
    s_mov_b32 s87, 0
L_sp59:
    ds_read_b32 v241, v240
    s_add_u32 s87, s87, 1
    s_waitcnt lgkmcnt(0)
    v_readfirstlane_b32 s86, v241
    s_cmp_ge_u32 s86, 1
    s_cbranch_scc1 L_sd60
    s_sleep 1
    s_cmp_lt_u32 s87, 200000
    s_cbranch_scc1 L_sp59
L_sd60:
    buffer_load_dwordx4 v[196:199], v246, s[40:43], s80 offen offset:0 sc1
    buffer_load_dwordx4 v[200:203], v13, s[40:43], s80 offen offset:1024 sc1
    buffer_load_dwordx4 v[204:207], v13, s[40:43], s80 offen offset:2048 sc1
    s_waitcnt vmcnt(6)
    v_mfma_f32_16x16x32_bf16 v[216:219], v[156:159], v[208:211], v[216:219]
    v_pk_add_f32 v[30:31], v[30:31], v[46:47]
    s_waitcnt lgkmcnt(5)
    v_pk_add_f32 v[52:53], v[52:53], v[56:57]
    v_mfma_f32_16x16x32_bf16 v[220:223], v[160:163], v[208:211], v[220:223]
    v_pk_add_f32 v[54:55], v[54:55], v[58:59]
    v_pk_add_f32 v[28:29], v[28:29], v[52:53]
    v_pk_add_f32 v[30:31], v[30:31], v[54:55]
    v_mfma_f32_16x16x32_bf16 v[224:227], v[164:167], v[208:211], v[224:227]
    v_cvt_pk_bf16_f32 v236, v28, v29
    v_cvt_pk_bf16_f32 v237, v30, v31
    buffer_store_dwordx2 v[236:237], v4, s[52:55], s77 offen
    v_mfma_f32_16x16x32_bf16 v[228:231], v[168:171], v[208:211], v[228:231]
    s_waitcnt lgkmcnt(2)
    v_lshlrev_b32_e64 v88, 16, v88
    v_pk_add_f32 v[80:81], v[80:81], v[82:83]
    v_mfma_f32_16x16x32_bf16 v[232:235], v[172:175], v[208:211], v[232:235]
    s_waitcnt lgkmcnt(0)
    v_pk_add_f32 v[84:85], v[84:85], v[86:87]
    v_add_f32 v80, v80, v88
    buffer_load_dwordx4 v[208:211], v13, s[40:43], s80 offen offset:3072 sc1
    s_waitcnt vmcnt(6)
    v_mfma_f32_16x16x32_bf16 v[216:219], v[176:179], v[212:215], v[216:219]
    v_pk_add_f32 v[80:81], v[80:81], v[84:85]
    v_add_f32 v80, v80, v81
    v_cvt_pk_bf16_f32 v80, v80, v80
    v_mfma_f32_16x16x32_bf16 v[220:223], v[180:183], v[212:215], v[220:223]
    buffer_store_short v80, v93, s[52:55], s77 offen
    v_mfma_f32_16x16x32_bf16 v[224:227], v[184:187], v[212:215], v[224:227]
    v_mfma_f32_16x16x32_bf16 v[228:231], v[188:191], v[212:215], v[228:231]
    ds_write_b128 v14, v[216:219] offset:0
    v_mfma_f32_16x16x32_bf16 v[232:235], v[192:195], v[212:215], v[232:235]
    ds_write_b128 v14, v[220:223] offset:1024
    buffer_load_dwordx4 v[212:215], v247, s[40:43], s81 offen offset:0 sc1
    s_waitcnt vmcnt(6)
    v_mfma_f32_16x16x32_bf16 v[216:219], v[96:99], v[196:199], 0
    ds_write_b128 v14, v[224:227] offset:2048
    v_mfma_f32_16x16x32_bf16 v[220:223], v[100:103], v[196:199], 0
    ds_write_b128 v14, v[228:231] offset:3072
    v_mfma_f32_16x16x32_bf16 v[224:227], v[104:107], v[196:199], 0
    ds_write_b128 v14, v[232:235] offset:4096
    v_mfma_f32_16x16x32_bf16 v[228:231], v[108:111], v[196:199], 0
    v_mfma_f32_16x16x32_bf16 v[232:235], v[112:115], v[196:199], 0
    s_waitcnt vmcnt(5)
    v_mfma_f32_16x16x32_bf16 v[216:219], v[116:119], v[200:203], v[216:219]
    v_mfma_f32_16x16x32_bf16 v[220:223], v[120:123], v[200:203], v[220:223]
    v_mfma_f32_16x16x32_bf16 v[224:227], v[124:127], v[200:203], v[224:227]
    v_mfma_f32_16x16x32_bf16 v[228:231], v[128:131], v[200:203], v[228:231]
    v_mfma_f32_16x16x32_bf16 v[232:235], v[132:135], v[200:203], v[232:235]
    s_waitcnt vmcnt(4)
    v_mfma_f32_16x16x32_bf16 v[216:219], v[136:139], v[204:207], v[216:219]
    v_mfma_f32_16x16x32_bf16 v[220:223], v[140:143], v[204:207], v[220:223]
    v_mfma_f32_16x16x32_bf16 v[224:227], v[144:147], v[204:207], v[224:227]
    v_mfma_f32_16x16x32_bf16 v[228:231], v[148:151], v[204:207], v[228:231]
    v_mfma_f32_16x16x32_bf16 v[232:235], v[152:155], v[204:207], v[232:235]
    s_waitcnt vmcnt(2)
    v_mfma_f32_16x16x32_bf16 v[216:219], v[156:159], v[208:211], v[216:219]
    v_mfma_f32_16x16x32_bf16 v[220:223], v[160:163], v[208:211], v[220:223]
    v_mfma_f32_16x16x32_bf16 v[224:227], v[164:167], v[208:211], v[224:227]
    v_mfma_f32_16x16x32_bf16 v[228:231], v[168:171], v[208:211], v[228:231]
    v_mfma_f32_16x16x32_bf16 v[232:235], v[172:175], v[208:211], v[232:235]
    s_waitcnt vmcnt(0)
    v_mfma_f32_16x16x32_bf16 v[216:219], v[176:179], v[212:215], v[216:219]
    v_mfma_f32_16x16x32_bf16 v[220:223], v[180:183], v[212:215], v[220:223]
    s_waitcnt lgkmcnt(0)
    s_barrier
    ds_read_b64_tr_b16 v[236:237], v3 offset:6144
    ds_read_b128 v[28:31], v16 offset:0
    ds_read_b128 v[32:35], v16 offset:5120
    v_mfma_f32_16x16x32_bf16 v[224:227], v[184:187], v[212:215], v[224:227]
    ds_read_b128 v[36:39], v16 offset:10240
    ds_read_b128 v[40:43], v16 offset:15360
    ds_read_b128 v[44:47], v16 offset:20480
    v_mfma_f32_16x16x32_bf16 v[228:231], v[188:191], v[212:215], v[228:231]
    ds_write_b128 v15, v[216:219] offset:0
    ds_read_b128 v[48:51], v16 offset:25600
    ds_read_b128 v[52:55], v16 offset:30720
    ds_read_b128 v[56:59], v16 offset:35840
    v_mfma_f32_16x16x32_bf16 v[232:235], v[192:195], v[212:215], v[232:235]
    ds_write_b128 v15, v[220:223] offset:1024
    ds_read_u16 v88, v92 offset:6144
    ds_read2st64_b32 v[80:81], v90 offset0:0 offset1:20
    ds_read2st64_b32 v[82:83], v90 offset0:40 offset1:60
    s_nop 5
    ds_write_b128 v15, v[224:227] offset:2048
    ds_write_b128 v15, v[228:231] offset:3072
    ds_write_b128 v15, v[232:235] offset:4096
    ds_read2st64_b32 v[84:85], v90 offset0:80 offset1:100
    ds_read2st64_b32 v[86:87], v90 offset0:120 offset1:140
    s_waitcnt lgkmcnt(15)
    v_lshlrev_b32 v238, 16, v236
    v_and_b32 v239, 0xffff0000, v236
    v_lshlrev_b32_e64 v236, 16, v237
    v_and_b32 v237, 0xffff0000, v237
    v_pk_add_f32 v[28:29], v[28:29], v[32:33]
    v_pk_add_f32 v[30:31], v[30:31], v[34:35]
    v_pk_add_f32 v[28:29], v[28:29], v[238:239]
    v_pk_add_f32 v[30:31], v[30:31], v[236:237]
    s_waitcnt lgkmcnt(14)
    v_pk_add_f32 v[36:37], v[36:37], v[40:41]
    v_pk_add_f32 v[38:39], v[38:39], v[42:43]
    v_pk_add_f32 v[28:29], v[28:29], v[36:37]
    v_pk_add_f32 v[30:31], v[30:31], v[38:39]
    s_waitcnt lgkmcnt(11)
    v_pk_add_f32 v[44:45], v[44:45], v[48:49]
    v_pk_add_f32 v[46:47], v[46:47], v[50:51]
    v_pk_add_f32 v[28:29], v[28:29], v[44:45]
    v_pk_add_f32 v[30:31], v[30:31], v[46:47]
    s_waitcnt lgkmcnt(9)
    v_pk_add_f32 v[52:53], v[52:53], v[56:57]
    v_pk_add_f32 v[54:55], v[54:55], v[58:59]
    v_pk_add_f32 v[28:29], v[28:29], v[52:53]
    v_pk_add_f32 v[30:31], v[30:31], v[54:55]
    v_cvt_pk_bf16_f32 v236, v28, v29
    v_cvt_pk_bf16_f32 v237, v30, v31
    buffer_store_dwordx2 v[236:237], v4, s[52:55], s78 offen
    s_waitcnt lgkmcnt(5)
    v_lshlrev_b32_e64 v88, 16, v88
    v_pk_add_f32 v[80:81], v[80:81], v[82:83]
    s_waitcnt lgkmcnt(0)
    v_pk_add_f32 v[84:85], v[84:85], v[86:87]
    v_add_f32 v80, v80, v88
    v_pk_add_f32 v[80:81], v[80:81], v[84:85]
    v_add_f32_e64 v80, v80, v81
    v_cvt_pk_bf16_f32 v80, v80, v80
    buffer_store_short v80, v93, s[52:55], s78 offen
    s_barrier
    ds_read_b64_tr_b16 v[236:237], v3 offset:9216
    ds_read_b128 v[28:31], v17 offset:0
    ds_read_b128 v[32:35], v17 offset:5120
    ds_read_b128 v[36:39], v17 offset:10240
    ds_read_b128 v[40:43], v17 offset:15360
    ds_read_b128 v[44:47], v17 offset:20480
    ds_read_b128 v[48:51], v17 offset:25600
    ds_read_b128 v[52:55], v17 offset:30720
    ds_read_b128 v[56:59], v17 offset:35840
    s_waitcnt lgkmcnt(8)
    v_lshlrev_b32_e64 v238, 16, v236
    v_and_b32 v239, 0xffff0000, v236
    v_lshlrev_b32_e64 v236, 16, v237
    v_and_b32 v237, 0xffff0000, v237
    s_waitcnt lgkmcnt(6)
    v_pk_add_f32 v[28:29], v[28:29], v[32:33]
    v_pk_add_f32 v[30:31], v[30:31], v[34:35]
    v_pk_add_f32 v[28:29], v[28:29], v[238:239]
    v_pk_add_f32 v[30:31], v[30:31], v[236:237]
    s_waitcnt lgkmcnt(4)
    v_pk_add_f32 v[36:37], v[36:37], v[40:41]
    v_pk_add_f32 v[38:39], v[38:39], v[42:43]
    v_pk_add_f32 v[28:29], v[28:29], v[36:37]
    v_pk_add_f32 v[30:31], v[30:31], v[38:39]
    s_waitcnt lgkmcnt(2)
    v_pk_add_f32 v[44:45], v[44:45], v[48:49]
    v_pk_add_f32 v[46:47], v[46:47], v[50:51]
    v_pk_add_f32 v[28:29], v[28:29], v[44:45]
    v_pk_add_f32 v[30:31], v[30:31], v[46:47]
    s_waitcnt lgkmcnt(0)
    v_pk_add_f32 v[52:53], v[52:53], v[56:57]
    v_pk_add_f32 v[54:55], v[54:55], v[58:59]
    v_pk_add_f32 v[28:29], v[28:29], v[52:53]
    v_pk_add_f32 v[30:31], v[30:31], v[54:55]
    v_cvt_pk_bf16_f32 v236, v28, v29
    v_cvt_pk_bf16_f32 v237, v30, v31
    buffer_store_dwordx2 v[236:237], v4, s[52:55], s79 offen
    s_waitcnt vmcnt(0)
    s_endpgm
L_idle2:
    s_sub_u32 s11, s2, 216
    s_bfe_u32 s33, s2, 0x20003
    s_lshl_b32 s33, s33, 1
    s_and_b32 s34, s2, 1
    s_add_u32 s33, s33, s34
    s_cmp_lt_u32 s2, 224
    s_cselect_b32 s11, s33, s11
    v_bfe_u32 v34, v2, 2, 2
    v_lshrrev_b32_e64 v35, 5, v2
    v_lshl_add_u32 v35, v35, 3, v34
    v_and_b32_e64 v34, 3, v2
    v_bfe_u32 v36, v2, 4, 1
    v_lshlrev_b32_e64 v4, 6, v35
    v_lshl_add_u32 v4, v36, 5, v4
    v_lshl_add_u32 v4, v34, 3, v4
    s_mul_i32 s34, s30, 10240
    s_add_u32 s35, s34, 40960
    v_add_u32_e64 v4, s35, v4
    s_mov_b32 s36, 0x3f803f80
    s_bfe_u32 s33, s11, 0x10004
    s_lshl_b32 s33, s33, 13
    s_add_u32 s38, s33, s8
    s_cmp_lg_u32 s30, 0
    s_cbranch_scc1 L_ow63
    buffer_load_dwordx4 v[28:31], v32, s[92:95], s38 offen sc1
    s_waitcnt vmcnt(0)
    s_mov_b32 s87, 0
L_pl65:
    v_xor_b32 v28, s56, v28
    v_xor_b32 v29, s56, v29
    v_xor_b32 v30, s56, v30
    v_xor_b32 v31, s56, v31
    v_or3_b32 v28, v28, v29, v30
    v_or_b32_e64 v28, v28, v31
    v_cmp_ne_u32 vcc, 0, v28
    s_add_u32 s87, s87, 1
    s_cbranch_vccz L_pd66
    s_sleep 8
    buffer_load_dwordx4 v[28:31], v32, s[92:95], s38 offen sc1
    s_cmp_lt_u32 s87, 20000
    s_waitcnt vmcnt(0)
    s_cbranch_scc1 L_pl65
L_pd66:
    v_mov_b32 v58, 83976
    v_mov_b32 v59, 1
    s_mov_b64 exec, 1
    ds_add_u32 v58, v59
    s_mov_b64 exec, -1
    s_branch L_dn64
L_ow63:
    v_mov_b32 v58, 83976
    s_mov_b32 s87, 0
L_sp67:
    ds_read_b32 v59, v58
    s_add_u32 s87, s87, 1
    s_waitcnt lgkmcnt(0)
    v_readfirstlane_b32 s86, v59
    s_cmp_ge_u32 s86, 1
    s_cbranch_scc1 L_sd68
    s_sleep 2
    s_cmp_lt_u32 s87, 200000
    s_cbranch_scc1 L_sp67
L_sd68:
L_dn64:
    s_cmp_ge_u32 s11, 32
    s_cbranch_scc1 L_j161
    s_mov_b32 s33, s11
    s_mul_i32 s37, s33, 40960
    s_add_u32 s37, s37, s34
    s_mov_b32 m0, s35
    buffer_load_dwordx4 v32, s[20:23], s37 offen offset:0 sc1 lds
    buffer_load_dwordx4 v32, s[20:23], s37 offen offset:1024 sc1 lds
    buffer_load_dwordx4 v32, s[20:23], s37 offen offset:2048 sc1 lds
    buffer_load_dwordx4 v32, s[20:23], s37 offen offset:3072 sc1 lds
    s_add_u32 m0, m0, 4096
    s_add_u32 s37, s37, 4096
    buffer_load_dwordx4 v32, s[20:23], s37 offen offset:0 sc1 lds
    buffer_load_dwordx4 v32, s[20:23], s37 offen offset:1024 sc1 lds
    buffer_load_dwordx4 v32, s[20:23], s37 offen offset:2048 sc1 lds
    buffer_load_dwordx4 v32, s[20:23], s37 offen offset:3072 sc1 lds
    s_add_u32 m0, m0, 4096
    s_add_u32 s37, s37, 4096
    buffer_load_dwordx4 v32, s[20:23], s37 offen offset:0 sc1 lds
    buffer_load_dwordx4 v32, s[20:23], s37 offen offset:1024 sc1 lds
    v_mov_b32 v16, 0
    v_mov_b32 v17, 0
    v_mov_b32 v18, 0
    v_mov_b32 v19, 0
    s_waitcnt vmcnt(9)
    ds_read_b64_tr_b16 v[64:65], v4 offset:0
    ds_read_b64_tr_b16 v[66:67], v4 offset:256
    s_waitcnt vmcnt(8)
    ds_read_b64_tr_b16 v[68:69], v4 offset:1024
    ds_read_b64_tr_b16 v[70:71], v4 offset:1280
    s_waitcnt vmcnt(7)
    ds_read_b64_tr_b16 v[72:73], v4 offset:2048
    ds_read_b64_tr_b16 v[74:75], v4 offset:2304
    s_waitcnt lgkmcnt(4)
    v_dot2c_f32_bf16 v16, s36, v64
    v_dot2c_f32_bf16 v18, v64, v64
    v_dot2c_f32_bf16 v17, s36, v65
    v_dot2c_f32_bf16 v19, v65, v65
    v_dot2c_f32_bf16 v16, s36, v66
    v_dot2c_f32_bf16 v18, v66, v66
    v_dot2c_f32_bf16 v17, s36, v67
    v_dot2c_f32_bf16 v19, v67, v67
    s_waitcnt vmcnt(6)
    ds_read_b64_tr_b16 v[76:77], v4 offset:3072
    ds_read_b64_tr_b16 v[78:79], v4 offset:3328
    s_waitcnt lgkmcnt(4)
    v_dot2c_f32_bf16 v16, s36, v68
    v_dot2c_f32_bf16 v18, v68, v68
    v_dot2c_f32_bf16 v17, s36, v69
    v_dot2c_f32_bf16 v19, v69, v69
    v_dot2c_f32_bf16 v16, s36, v70
    v_dot2c_f32_bf16 v18, v70, v70
    v_dot2c_f32_bf16 v17, s36, v71
    v_dot2c_f32_bf16 v19, v71, v71
    s_waitcnt vmcnt(5)
    ds_read_b64_tr_b16 v[80:81], v4 offset:4096
    ds_read_b64_tr_b16 v[82:83], v4 offset:4352
    s_waitcnt lgkmcnt(4)
    v_dot2c_f32_bf16 v16, s36, v72
    v_dot2c_f32_bf16 v18, v72, v72
    v_dot2c_f32_bf16 v17, s36, v73
    v_dot2c_f32_bf16 v19, v73, v73
    v_dot2c_f32_bf16 v16, s36, v74
    v_dot2c_f32_bf16 v18, v74, v74
    v_dot2c_f32_bf16 v17, s36, v75
    v_dot2c_f32_bf16 v19, v75, v75
    s_waitcnt vmcnt(4)
    ds_read_b64_tr_b16 v[84:85], v4 offset:5120
    ds_read_b64_tr_b16 v[86:87], v4 offset:5376
    s_waitcnt lgkmcnt(4)
    v_dot2c_f32_bf16 v16, s36, v76
    v_dot2c_f32_bf16 v18, v76, v76
    v_dot2c_f32_bf16 v17, s36, v77
    v_dot2c_f32_bf16 v19, v77, v77
    v_dot2c_f32_bf16 v16, s36, v78
    v_dot2c_f32_bf16 v18, v78, v78
    v_dot2c_f32_bf16 v17, s36, v79
    v_dot2c_f32_bf16 v19, v79, v79
    s_waitcnt vmcnt(3)
    ds_read_b64_tr_b16 v[88:89], v4 offset:6144
    ds_read_b64_tr_b16 v[90:91], v4 offset:6400
    s_waitcnt lgkmcnt(4)
    v_dot2c_f32_bf16 v16, s36, v80
    v_dot2c_f32_bf16 v18, v80, v80
    v_dot2c_f32_bf16 v17, s36, v81
    v_dot2c_f32_bf16 v19, v81, v81
    v_dot2c_f32_bf16 v16, s36, v82
    v_dot2c_f32_bf16 v18, v82, v82
    v_dot2c_f32_bf16 v17, s36, v83
    v_dot2c_f32_bf16 v19, v83, v83
    s_waitcnt vmcnt(2)
    ds_read_b64_tr_b16 v[92:93], v4 offset:7168
    ds_read_b64_tr_b16 v[94:95], v4 offset:7424
    s_waitcnt lgkmcnt(4)
    v_dot2c_f32_bf16 v16, s36, v84
    v_dot2c_f32_bf16 v18, v84, v84
    v_dot2c_f32_bf16 v17, s36, v85
    v_dot2c_f32_bf16 v19, v85, v85
    v_dot2c_f32_bf16 v16, s36, v86
    v_dot2c_f32_bf16 v18, v86, v86
    v_dot2c_f32_bf16 v17, s36, v87
    v_dot2c_f32_bf16 v19, v87, v87
    s_waitcnt vmcnt(1)
    ds_read_b64_tr_b16 v[96:97], v4 offset:8192
    ds_read_b64_tr_b16 v[98:99], v4 offset:8448
    s_waitcnt lgkmcnt(4)
    v_dot2c_f32_bf16 v16, s36, v88
    v_dot2c_f32_bf16 v18, v88, v88
    v_dot2c_f32_bf16 v17, s36, v89
    v_dot2c_f32_bf16 v19, v89, v89
    v_dot2c_f32_bf16 v16, s36, v90
    v_dot2c_f32_bf16 v18, v90, v90
    v_dot2c_f32_bf16 v17, s36, v91
    v_dot2c_f32_bf16 v19, v91, v91
    s_waitcnt vmcnt(0)
    ds_read_b64_tr_b16 v[100:101], v4 offset:9216
    ds_read_b64_tr_b16 v[102:103], v4 offset:9472
    s_waitcnt lgkmcnt(4)
    v_dot2c_f32_bf16 v16, s36, v92
    v_dot2c_f32_bf16 v18, v92, v92
    v_dot2c_f32_bf16 v17, s36, v93
    v_dot2c_f32_bf16 v19, v93, v93
    v_dot2c_f32_bf16 v16, s36, v94
    v_dot2c_f32_bf16 v18, v94, v94
    v_dot2c_f32_bf16 v17, s36, v95
    v_dot2c_f32_bf16 v19, v95, v95
    s_waitcnt lgkmcnt(2)
    v_dot2c_f32_bf16 v16, s36, v96
    v_dot2c_f32_bf16 v18, v96, v96
    v_dot2c_f32_bf16 v17, s36, v97
    v_dot2c_f32_bf16 v19, v97, v97
    v_dot2c_f32_bf16 v16, s36, v98
    v_dot2c_f32_bf16 v18, v98, v98
    v_dot2c_f32_bf16 v17, s36, v99
    v_dot2c_f32_bf16 v19, v99, v99
    s_waitcnt lgkmcnt(0)
    v_dot2c_f32_bf16 v16, s36, v100
    v_dot2c_f32_bf16 v18, v100, v100
    v_dot2c_f32_bf16 v17, s36, v101
    v_dot2c_f32_bf16 v19, v101, v101
    v_dot2c_f32_bf16 v16, s36, v102
    v_dot2c_f32_bf16 v18, v102, v102
    v_dot2c_f32_bf16 v17, s36, v103
    v_dot2c_f32_bf16 v19, v103, v103
    s_lshl_b32 s37, s30, 8
    s_add_u32 s37, s37, 81920
    v_lshl_add_u32 v20, v2, 2, s37
    s_nop 0
    v_add_f32 v16, v16, v17
    v_add_f32 v18, v18, v19
    s_nop 1
    v_permlane32_swap_b32 v16, v18
    s_nop 1
    v_add_f32_e64 v16, v16, v18
    ds_write_b32 v20, v16
    s_waitcnt lgkmcnt(0)
    v_mov_b32 v58, 83968
    v_mov_b32 v59, 1
    s_mov_b64 exec, 1
    ds_add_rtn_u32 v59, v58, v59
    s_waitcnt lgkmcnt(0)
    v_readfirstlane_b32 s86, v59
    s_mov_b64 exec, -1
    s_cmp_lg_u32 s86, 3
    s_cbranch_scc1 L_j161
    v_lshlrev_b32_e64 v20, 2, v2
    v_add_u32 v20, 81920, v20
    s_mov_b32 exec_hi, 0
    ds_read2_b32 v[16:17], v20 offset0:0 offset1:32
    ds_read2_b32 v[18:19], v20 offset0:64 offset1:96
    ds_read2_b32 v[22:23], v20 offset0:128 offset1:160
    ds_read2_b32 v[24:25], v20 offset0:192 offset1:224
    s_waitcnt lgkmcnt(0)
    v_pk_add_f32 v[16:17], v[16:17], v[18:19]
    v_pk_add_f32 v[22:23], v[22:23], v[24:25]
    v_pk_add_f32 v[16:17], v[16:17], v[22:23]
    v_mul_f32 v21, 986500301, v16
    v_mul_f32 v22, 986500301, v17
    v_fma_f32 v22, -v21, v21, v22
    v_max_f32_e64 v22, 0, v22
    v_cvt_pk_bf16_f32 v22, v22, v22
    v_and_b32 v22, 0xffff0000, v22
    v_add_f32 v22, 0x3727c5ac, v22
    v_cvt_pk_bf16_f32 v22, v22, v22
    v_and_b32 v22, 0xffff0000, v22
    v_sqrt_f32 v22, v22
    s_nop 0
    v_cvt_pk_bf16_f32 v22, v22, v22
    v_and_b32 v22, 0xffff0000, v22
    v_cvt_pk_bf16_f32 v21, v21, v21
    v_and_b32 v21, 0xffff0000, v21
    v_rcp_f32 v29, v22
    v_sub_f32 v28, 0, v21
    v_cvt_pk_bf16_f32 v28, v28, v28
    v_mul_f32 v29, 3216550459, v29
    v_mul_f32 v30, v22, v22
    v_mov_b32 v31, s56
    v_and_b32 v29, 0xffffff7f, v29
    v_and_b32 v30, 0xffffff7f, v30
    s_lshl_b32 s37, s33, 9
    buffer_store_dwordx4 v[28:31], v32, s[24:27], s37 offen sc1
    s_mov_b32 exec_hi, -1
L_j161:
    s_waitcnt lgkmcnt(0)
    s_barrier
    s_cmp_lg_u32 s30, 0
    s_cbranch_scc1 L_ow69
    buffer_load_dwordx4 v[28:31], v32, s[92:95], s10 offen sc1
    s_waitcnt vmcnt(0)
    s_mov_b32 s87, 0
L_pl71:
    v_xor_b32 v28, s56, v28
    v_xor_b32 v29, s56, v29
    v_xor_b32 v30, s56, v30
    v_xor_b32 v31, s56, v31
    v_or3_b32 v28, v28, v29, v30
    v_or_b32_e64 v28, v28, v31
    v_cmp_ne_u32 vcc, 0, v28
    s_add_u32 s87, s87, 1
    s_cbranch_vccz L_pd72
    s_sleep 8
    buffer_load_dwordx4 v[28:31], v32, s[92:95], s10 offen sc1
    s_cmp_lt_u32 s87, 20000
    s_waitcnt vmcnt(0)
    s_cbranch_scc1 L_pl71
L_pd72:
    v_mov_b32 v58, 83980
    v_mov_b32 v59, 1
    s_mov_b64 exec, 1
    ds_add_u32 v58, v59
    s_mov_b64 exec, -1
    s_branch L_dn70
L_ow69:
    v_mov_b32 v58, 83980
    s_mov_b32 s87, 0
L_sp73:
    ds_read_b32 v59, v58
    s_add_u32 s87, s87, 1
    s_waitcnt lgkmcnt(0)
    v_readfirstlane_b32 s86, v59
    s_cmp_ge_u32 s86, 1
    s_cbranch_scc1 L_sd74
    s_sleep 2
    s_cmp_lt_u32 s87, 200000
    s_cbranch_scc1 L_sp73
L_sd74:
L_dn70:
    s_cmp_lt_u32 s11, 8
    s_cbranch_scc1 L_j262
    s_sub_u32 s33, 71, s11
    s_mul_i32 s37, s33, 40960
    s_add_u32 s37, s37, s34
    s_mov_b32 m0, s35
    buffer_load_dwordx4 v32, s[20:23], s37 offen offset:0 sc1 lds
    buffer_load_dwordx4 v32, s[20:23], s37 offen offset:1024 sc1 lds
    buffer_load_dwordx4 v32, s[20:23], s37 offen offset:2048 sc1 lds
    buffer_load_dwordx4 v32, s[20:23], s37 offen offset:3072 sc1 lds
    s_add_u32 m0, m0, 4096
    s_add_u32 s37, s37, 4096
    buffer_load_dwordx4 v32, s[20:23], s37 offen offset:0 sc1 lds
    buffer_load_dwordx4 v32, s[20:23], s37 offen offset:1024 sc1 lds
    buffer_load_dwordx4 v32, s[20:23], s37 offen offset:2048 sc1 lds
    buffer_load_dwordx4 v32, s[20:23], s37 offen offset:3072 sc1 lds
    s_add_u32 m0, m0, 4096
    s_add_u32 s37, s37, 4096
    buffer_load_dwordx4 v32, s[20:23], s37 offen offset:0 sc1 lds
    buffer_load_dwordx4 v32, s[20:23], s37 offen offset:1024 sc1 lds
    v_mov_b32 v16, 0
    v_mov_b32 v17, 0
    v_mov_b32_e64 v18, 0
    v_mov_b32 v19, 0
    s_waitcnt vmcnt(9)
    ds_read_b64_tr_b16 v[64:65], v4 offset:0
    ds_read_b64_tr_b16 v[66:67], v4 offset:256
    s_waitcnt vmcnt(8)
    ds_read_b64_tr_b16 v[68:69], v4 offset:1024
    ds_read_b64_tr_b16 v[70:71], v4 offset:1280
    s_waitcnt vmcnt(7)
    ds_read_b64_tr_b16 v[72:73], v4 offset:2048
    ds_read_b64_tr_b16 v[74:75], v4 offset:2304
    s_waitcnt lgkmcnt(4)
    v_dot2c_f32_bf16 v16, s36, v64
    v_dot2c_f32_bf16 v18, v64, v64
    v_dot2c_f32_bf16 v17, s36, v65
    v_dot2c_f32_bf16 v19, v65, v65
    v_dot2c_f32_bf16 v16, s36, v66
    v_dot2c_f32_bf16 v18, v66, v66
    v_dot2c_f32_bf16 v17, s36, v67
    v_dot2c_f32_bf16 v19, v67, v67
    s_waitcnt vmcnt(6)
    ds_read_b64_tr_b16 v[76:77], v4 offset:3072
    ds_read_b64_tr_b16 v[78:79], v4 offset:3328
    s_waitcnt lgkmcnt(4)
    v_dot2c_f32_bf16 v16, s36, v68
    v_dot2c_f32_bf16 v18, v68, v68
    v_dot2c_f32_bf16 v17, s36, v69
    v_dot2c_f32_bf16 v19, v69, v69
    v_dot2c_f32_bf16 v16, s36, v70
    v_dot2c_f32_bf16 v18, v70, v70
    v_dot2c_f32_bf16 v17, s36, v71
    v_dot2c_f32_bf16 v19, v71, v71
    s_waitcnt vmcnt(5)
    ds_read_b64_tr_b16 v[80:81], v4 offset:4096
    ds_read_b64_tr_b16 v[82:83], v4 offset:4352
    s_waitcnt lgkmcnt(4)
    v_dot2c_f32_bf16 v16, s36, v72
    v_dot2c_f32_bf16 v18, v72, v72
    v_dot2c_f32_bf16 v17, s36, v73
    v_dot2c_f32_bf16 v19, v73, v73
    v_dot2c_f32_bf16 v16, s36, v74
    v_dot2c_f32_bf16 v18, v74, v74
    v_dot2c_f32_bf16 v17, s36, v75
    v_dot2c_f32_bf16 v19, v75, v75
    s_waitcnt vmcnt(4)
    ds_read_b64_tr_b16 v[84:85], v4 offset:5120
    ds_read_b64_tr_b16 v[86:87], v4 offset:5376
    s_waitcnt lgkmcnt(4)
    v_dot2c_f32_bf16 v16, s36, v76
    v_dot2c_f32_bf16 v18, v76, v76
    v_dot2c_f32_bf16 v17, s36, v77
    v_dot2c_f32_bf16 v19, v77, v77
    v_dot2c_f32_bf16 v16, s36, v78
    v_dot2c_f32_bf16 v18, v78, v78
    v_dot2c_f32_bf16 v17, s36, v79
    v_dot2c_f32_bf16 v19, v79, v79
    s_waitcnt vmcnt(3)
    ds_read_b64_tr_b16 v[88:89], v4 offset:6144
    ds_read_b64_tr_b16 v[90:91], v4 offset:6400
    s_waitcnt lgkmcnt(4)
    v_dot2c_f32_bf16 v16, s36, v80
    v_dot2c_f32_bf16 v18, v80, v80
    v_dot2c_f32_bf16 v17, s36, v81
    v_dot2c_f32_bf16 v19, v81, v81
    v_dot2c_f32_bf16 v16, s36, v82
    v_dot2c_f32_bf16 v18, v82, v82
    v_dot2c_f32_bf16 v17, s36, v83
    v_dot2c_f32_bf16 v19, v83, v83
    s_waitcnt vmcnt(2)
    ds_read_b64_tr_b16 v[92:93], v4 offset:7168
    ds_read_b64_tr_b16 v[94:95], v4 offset:7424
    s_waitcnt lgkmcnt(4)
    v_dot2c_f32_bf16 v16, s36, v84
    v_dot2c_f32_bf16 v18, v84, v84
    v_dot2c_f32_bf16 v17, s36, v85
    v_dot2c_f32_bf16 v19, v85, v85
    v_dot2c_f32_bf16 v16, s36, v86
    v_dot2c_f32_bf16 v18, v86, v86
    v_dot2c_f32_bf16 v17, s36, v87
    v_dot2c_f32_bf16 v19, v87, v87
    s_waitcnt vmcnt(1)
    ds_read_b64_tr_b16 v[96:97], v4 offset:8192
    ds_read_b64_tr_b16 v[98:99], v4 offset:8448
    s_waitcnt lgkmcnt(4)
    v_dot2c_f32_bf16 v16, s36, v88
    v_dot2c_f32_bf16 v18, v88, v88
    v_dot2c_f32_bf16 v17, s36, v89
    v_dot2c_f32_bf16 v19, v89, v89
    v_dot2c_f32_bf16 v16, s36, v90
    v_dot2c_f32_bf16 v18, v90, v90
    v_dot2c_f32_bf16 v17, s36, v91
    v_dot2c_f32_bf16 v19, v91, v91
    s_waitcnt vmcnt(0)
    ds_read_b64_tr_b16 v[100:101], v4 offset:9216
    ds_read_b64_tr_b16 v[102:103], v4 offset:9472
    s_waitcnt lgkmcnt(4)
    v_dot2c_f32_bf16 v16, s36, v92
    v_dot2c_f32_bf16 v18, v92, v92
    v_dot2c_f32_bf16 v17, s36, v93
    v_dot2c_f32_bf16 v19, v93, v93
    v_dot2c_f32_bf16 v16, s36, v94
    v_dot2c_f32_bf16 v18, v94, v94
    v_dot2c_f32_bf16 v17, s36, v95
    v_dot2c_f32_bf16 v19, v95, v95
    s_waitcnt lgkmcnt(2)
    v_dot2c_f32_bf16 v16, s36, v96
    v_dot2c_f32_bf16 v18, v96, v96
    v_dot2c_f32_bf16 v17, s36, v97
    v_dot2c_f32_bf16 v19, v97, v97
    v_dot2c_f32_bf16 v16, s36, v98
    v_dot2c_f32_bf16 v18, v98, v98
    v_dot2c_f32_bf16 v17, s36, v99
    v_dot2c_f32_bf16 v19, v99, v99
    s_waitcnt lgkmcnt(0)
    v_dot2c_f32_bf16 v16, s36, v100
    v_dot2c_f32_bf16 v18, v100, v100
    v_dot2c_f32_bf16 v17, s36, v101
    v_dot2c_f32_bf16 v19, v101, v101
    v_dot2c_f32_bf16 v16, s36, v102
    v_dot2c_f32_bf16 v18, v102, v102
    v_dot2c_f32_bf16 v17, s36, v103
    v_dot2c_f32_bf16 v19, v103, v103
    s_lshl_b32 s37, s30, 8
    s_add_u32 s37, s37, 82944
    v_lshl_add_u32 v20, v2, 2, s37
    s_nop 0
    v_add_f32 v16, v16, v17
    v_add_f32 v18, v18, v19
    s_nop 1
    v_permlane32_swap_b32 v16, v18
    s_nop 1
    v_add_f32_e64 v16, v16, v18
    ds_write_b32 v20, v16
    s_waitcnt lgkmcnt(0)
    v_mov_b32 v58, 83972
    v_mov_b32 v59, 1
    s_mov_b64 exec, 1
    ds_add_rtn_u32 v59, v58, v59
    s_waitcnt lgkmcnt(0)
    v_readfirstlane_b32 s86, v59
    s_mov_b64 exec, -1
    s_cmp_lg_u32 s86, 3
    s_cbranch_scc1 L_j262
    v_lshlrev_b32_e64 v20, 2, v2
    v_add_u32 v20, 82944, v20
    s_mov_b32 exec_hi, 0
    ds_read2_b32 v[16:17], v20 offset0:0 offset1:32
    ds_read2_b32 v[18:19], v20 offset0:64 offset1:96
    ds_read2_b32 v[22:23], v20 offset0:128 offset1:160
    ds_read2_b32 v[24:25], v20 offset0:192 offset1:224
    s_waitcnt lgkmcnt(0)
    v_pk_add_f32 v[16:17], v[16:17], v[18:19]
    v_pk_add_f32 v[22:23], v[22:23], v[24:25]
    v_pk_add_f32 v[16:17], v[16:17], v[22:23]
    v_mul_f32 v21, 986500301, v16
    v_mul_f32 v22, 986500301, v17
    v_fma_f32 v22, -v21, v21, v22
    v_max_f32_e64 v22, 0, v22
    v_cvt_pk_bf16_f32 v22, v22, v22
    v_and_b32 v22, 0xffff0000, v22
    v_add_f32 v22, 0x3727c5ac, v22
    v_cvt_pk_bf16_f32 v22, v22, v22
    v_and_b32 v22, 0xffff0000, v22
    v_sqrt_f32 v22, v22
    s_nop 0
    v_cvt_pk_bf16_f32 v22, v22, v22
    v_and_b32 v22, 0xffff0000, v22
    v_cvt_pk_bf16_f32 v21, v21, v21
    v_and_b32 v21, 0xffff0000, v21
    v_rcp_f32 v29, v22
    v_sub_f32 v28, 0, v21
    v_cvt_pk_bf16_f32 v28, v28, v28
    v_mul_f32 v29, 3216550459, v29
    v_mul_f32 v30, v22, v22
    v_mov_b32 v31, s56
    v_and_b32 v29, 0xffffff7f, v29
    v_and_b32 v30, 0xffffff7f, v30
    s_lshl_b32 s37, s33, 9
    buffer_store_dwordx4 v[28:31], v32, s[24:27], s37 offen sc1
    s_mov_b32 exec_hi, -1
L_j262:
    v_mov_b32 v12, 0x7ff00000
    v_mov_b32 v11, 0
    s_mov_b32 s29, 0
    v_lshlrev_b32 v13, 4, v2
    s_mul_i32 s35, s30, 5
    s_cmp_eq_u32 s30, 3
    s_cselect_b32 s35, 13, s35
    s_mul_i32 s33, s35, 5120
    s_add_u32 s33, s33, 86016
    v_add_u32_e64 v244, s33, v13
    s_add_u32 s33, s33, 10240
    s_cmp_eq_u32 s30, 3
    s_cselect_b32 s33, 0, s33
    v_add_u32 v245, s33, v13
    s_add_u32 s35, s35, 36
    s_lshl_b32 s83, s35, 10
    s_add_u32 s80, s72, s83
    s_add_u32 s81, s80, 4096
    s_cmp_eq_u32 s30, 3
    s_cselect_b32 s35, 0x7ff00000, 0
    v_or_b32 v246, s35, v13
    s_cmp_eq_u32 s30, 2
    s_cselect_b32 s35, 0x7ff00000, 0
    v_or_b32 v247, s35, v13
    s_waitcnt vmcnt(0) lgkmcnt(0)
    s_barrier
    buffer_load_dwordx4 v[196:199], v246, s[40:43], s80 offen offset:0 sc1
    buffer_load_dwordx4 v[200:203], v13, s[40:43], s80 offen offset:1024 sc1
    buffer_load_dwordx4 v[204:207], v13, s[40:43], s80 offen offset:2048 sc1
    buffer_load_dwordx4 v[208:211], v13, s[40:43], s80 offen offset:3072 sc1
    buffer_load_dwordx4 v[212:215], v247, s[40:43], s81 offen offset:0 sc1
    ds_read_b128 v[96:99], v244 offset:0
    ds_read_b128 v[100:103], v244 offset:1024
    ds_read_b128 v[104:107], v244 offset:2048
    ds_read_b128 v[108:111], v244 offset:3072
    ds_read_b128 v[112:115], v244 offset:4096
    ds_read_b128 v[116:119], v244 offset:5120
    ds_read_b128 v[120:123], v244 offset:6144
    ds_read_b128 v[124:127], v244 offset:7168
    ds_read_b128 v[128:131], v244 offset:8192
    ds_read_b128 v[132:135], v244 offset:9216
    buffer_store_dword v11, v12, s[48:51], s29 offen
    s_branch L_g2w4
L_hp6:
    s_bitcmp1_b32 s64, 0
    s_cselect_b32 s24, s26, s24
    s_cselect_b32 s25, s27, s25
    s_mov_b32 s26, 163840
    s_mov_b32 s27, 0x00020000
    s_mul_i32 s70, s64, 768
    s_add_u32 m0, s70, 144384
    s_lshl_b32 s70, s66, 8
    s_mov_b32 exec_hi, 0xffff
    buffer_load_dwordx4 v5, s[24:27], s70 offen lds
    s_mov_b32 exec_hi, -1
    s_mov_b32 s40, s84
    s_mov_b32 s41, s85
    s_mov_b32 s42, 2211840
    s_mov_b32 s43, 0x00020000
    s_cmp_ge_u32 s2, 216
    s_cselect_b32 s42, 0, s42
    s_lshr_b32 s77, s2, 2
    s_mul_i32 s77, s77, 40960
    s_and_b32 s78, s2, 3
    s_mul_i32 s78, s78, 320
    s_add_u32 s77, s77, s78
    s_and_b32 s76, s64, 3
    s_lshl_b32 s71, s76, 6
    v_add_u32 v39, s71, v2
    s_lshl_b32 s78, s76, 10
    s_add_u32 m0, s78, 90112
    s_movk_i32 s70, 3277
    s_movk_i32 s71, 960
    v_mul_u32_u24 v30, s70, v39
    v_lshlrev_b32 v40, 4, v39
    v_lshrrev_b32_e64 v30, 16, v30
    v_add_u32 v39, 256, v39
    v_mad_u32_u24 v40, v30, s71, v40
    buffer_load_dwordx4 v40, s[40:43], s77 offen lds
    s_add_u32 m0, m0, 4096
    v_mul_u32_u24 v30, s70, v39
    v_lshlrev_b32 v41, 4, v39
    v_lshrrev_b32_e64 v30, 16, v30
    v_add_u32 v39, 256, v39
    v_mad_u32_u24 v41, v30, s71, v41
    buffer_load_dwordx4 v41, s[40:43], s77 offen lds
    s_add_u32 m0, m0, 4096
    v_mul_u32_u24 v30, s70, v39
    v_lshlrev_b32 v42, 4, v39
    v_lshrrev_b32_e64 v30, 16, v30
    v_mad_u32_u24 v42, v30, s71, v42
    s_cmp_ge_u32 s76, 2
    s_cselect_b32 s77, 0x7ff00000, s77
    buffer_load_dwordx4 v42, s[40:43], s77 offen lds
    s_lshl_b32 s78, s76, 5
    s_add_u32 s78, s78, 90112
    s_barrier
    s_mov_b32 s60, s100
    s_mov_b32 s61, s101
    s_mov_b32 s62, 16384
    s_mov_b32 s63, 0x00020000
    s_mov_b32 s52, s86
    s_mov_b32 s53, s87
    s_mov_b32 s54, 2621440
    s_mov_b32 s55, 0x00020000
    s_lshr_b32 s70, s2, 5
    s_bfe_u32 s71, s2, 0x20001
    s_mul_i32 s71, s71, 7
    s_add_u32 s71, s71, s70
    s_cmp_ge_u32 s70, 7
    s_cselect_b32 s57, 27, s71
    s_lshl_b32 s67, s57, 7
    s_and_b32 s70, s64, 1
    s_mul_i32 s71, s70, 27648
    s_add_u32 s67, s67, s71
    s_cmp_lt_u32 s57, 27
    s_cselect_b32 s58, 1, 0
    s_lshl_b32 s70, s70, 7
    s_add_u32 s70, s70, 147456
    v_lshl_add_u32 v80, v2, 1, s70
    s_and_b32 s76, s64, 3
    s_add_u32 s44, s100, 29360128
    s_addc_u32 s45, s101, 0
    s_mov_b32 s46, 2211840
    s_mov_b32 s47, 0x00020000
    v_and_b32_e64 v30, 1, v2
    v_bfe_u32 v31, v2, 4, 1
    v_lshrrev_b32_e64 v32, 5, v2
    v_bfe_u32 v33, v2, 2, 2
    v_bfe_u32 v34, v2, 2, 3
    v_lshl_add_u32 v35, v32, 3, v33
    v_and_b32_e64 v36, 3, v2
    v_bfe_u32 v37, v2, 1, 1
    v_and_b32_e64 v39, 31, v2
    v_lshl_add_u32 v40, v32, 2, v31
    v_lshl_add_u32 v40, v40, 2, v33
    v_mul_u32_u24 v83, 320, v40
    v_lshl_add_u32 v83, v36, 3, v83
    v_add_u32 v83, s78, v83
    v_lshrrev_b32 v40, 3, v39
    v_bfe_u32 v41, v39, 2, 1
    v_min_u32_e64 v42, 2, v36
    v_lshl_add_u32 v42, v41, 1, v42
    v_add_u32_e64 v42, 8, v42
    v_add3_u32 v43, v37, v36, v41
    v_add_u32_e64 v43, 13, v43
    v_lshl_add_u32 v44, v36, 1, v41
    v_cmp_eq_u32_e64 vcc, 1, v40
    v_cmp_eq_u32 s[70:71], 2, v40
    v_cmp_eq_u32 s[72:73], 3, v40
    s_mul_i32 s74, s76, 10032
    s_mul_i32 s75, s76, 4224
    v_cndmask_b32_e64 v42, v39, v42, vcc
    v_cndmask_b32 v42, v42, v43, s[70:71]
    v_cndmask_b32 v42, v42, v44, s[72:73]
    s_add_u32 s74, s74, 50688
    s_add_u32 s75, s75, 114304
    v_mov_b32 v43, s74
    v_mov_b32 v44, s75
    v_mul_u32_u24 v84, 528, v42
    v_cndmask_b32 v43, v43, v44, s[72:73]
    v_lshl_add_u32 v84, v32, 4, v84
    v_add_u32_e64 v84, v43, v84
    s_mul_i32 s74, s76, 16896
    v_mul_u32_u24 v85, 528, v39
    v_lshl_add_u32 v85, v32, 4, v85
    v_add_u32 v85, s74, v85
    v_lshlrev_b32 v86, 4, v39
    v_lshl_add_u32 v86, v32, 3, v86
    v_add_u32 v86, s75, v86
    s_waitcnt vmcnt(4) lgkmcnt(0)
    s_add_u32 s56, s56, 1
    v_lshlrev_b32 v28, 16, v16
    v_and_b32 v29, 0xffff0000, v16
    v_lshlrev_b32_e64 v30, 16, v17
    v_and_b32 v31, 0xffff0000, v17
    v_lshlrev_b32_e64 v32, 16, v18
    v_and_b32 v33, 0xffff0000, v18
    v_lshlrev_b32_e64 v34, 16, v19
    v_and_b32 v35, 0xffff0000, v19
    v_lshlrev_b32_e64 v36, 16, v20
    v_and_b32 v37, 0xffff0000, v20
    v_pk_add_f32 v[16:17], v[28:29], v[30:31]
    v_pk_mul_f32 v[18:19], v[28:29], v[28:29]
    v_pk_add_f32 v[20:21], v[32:33], v[34:35]
    v_pk_fma_f32 v[18:19], v[30:31], v[30:31], v[18:19]
    v_pk_add_f32 v[16:17], v[16:17], v[36:37]
    v_pk_fma_f32 v[18:19], v[32:33], v[32:33], v[18:19]
    v_pk_add_f32 v[16:17], v[16:17], v[20:21]
    v_pk_fma_f32 v[18:19], v[34:35], v[34:35], v[18:19]
    v_pk_fma_f32 v[18:19], v[36:37], v[36:37], v[18:19]
    v_add_f32 v16, v16, v17
    v_add_f32 v18, v18, v19
    s_and_b32 s70, s66, 1
    s_lshl_b32 s70, s70, 4
    v_add_f32_dpp v16, v16, v16 row_shr:1 row_mask:0xf bank_mask:0xf bound_ctrl:0
    v_add_f32_dpp v18, v18, v18 row_shr:1 row_mask:0xf bank_mask:0xf bound_ctrl:0
    s_lshr_b64 s[8:9], s[8:9], s70
    v_add_f32_dpp v16, v16, v16 row_shr:2 row_mask:0xf bank_mask:0xf bound_ctrl:0
    v_add_f32_dpp v18, v18, v18 row_shr:2 row_mask:0xf bank_mask:0xf bound_ctrl:0
    s_lshr_b64 s[10:11], s[10:11], s70
    v_add_f32_dpp v16, v16, v16 row_shr:4 row_mask:0xf bank_mask:0xf bound_ctrl:0
    v_add_f32_dpp v18, v18, v18 row_shr:4 row_mask:0xf bank_mask:0xf bound_ctrl:0
    s_lshl_b32 s70, s76, 4
    v_add_f32_dpp v16, v16, v16 row_shr:8 row_mask:0xf bank_mask:0xf bound_ctrl:0
    v_add_f32_dpp v18, v18, v18 row_shr:8 row_mask:0xf bank_mask:0xf bound_ctrl:0
    s_lshr_b64 s[10:11], s[10:11], s70
    v_add_f32_dpp v16, v16, v16 row_bcast:15 row_mask:0xa bank_mask:0xf
    v_add_f32_dpp v18, v18, v18 row_bcast:15 row_mask:0xa bank_mask:0xf
    s_lshl_b32 s3, s10, 16
    v_add_f32_dpp v16, v16, v16 row_bcast:31 row_mask:0xc bank_mask:0xf
    v_add_f32_dpp v18, v18, v18 row_bcast:31 row_mask:0xc bank_mask:0xf
    s_lshl_b32 s70, s8, 16
    s_and_b32 s71, s8, 0xffff0000
    s_lshl_b32 s74, s9, 16
    v_mov_b32 v68, s70
    v_mov_b32 v69, s71
    v_mov_b32 v70, s74
    v_readlane_b32 s72, v16, 63
    v_readlane_b32 s73, v18, 63
    v_mov_b32 v20, 986500301
    s_nop 1
    v_mul_f32 v16, s72, v20
    v_mul_f32_e64 v18, s73, v20
    v_fma_f32 v18, -v16, v16, v18
    v_max_f32_e64 v18, 0, v18
    v_cvt_pk_bf16_f32 v18, v18, v18
    v_and_b32 v18, 0xffff0000, v18
    v_add_f32 v18, 0x3727c5ac, v18
    v_cvt_pk_bf16_f32 v18, v18, v18
    v_and_b32 v18, 0xffff0000, v18
    v_sqrt_f32_e64 v18, v18
    v_cvt_pk_bf16_f32 v16, v16, v16
    v_and_b32 v16, 0xffff0000, v16
    v_cvt_pk_bf16_f32 v18, v18, v18
    v_and_b32 v18, 0xffff0000, v18
    s_lshl_b32 s72, s64, 3
    s_lshl_b32 s73, s2, 6
    v_lshrrev_b32 v16, 16, v16
    v_mov_b32 v17, s56
    v_or_b32_e64 v16, v16, v18
    s_add_u32 s72, s72, 151552
    v_mov_b32 v20, s72
    s_mov_b64 exec, 1
    ds_write_b64 v20, v[16:17]
    s_mov_b64 exec, -1
    s_waitcnt vmcnt(3) lgkmcnt(0)
    s_barrier
    s_cmp_lg_u32 s64, 7
    s_cbranch_scc1 L_ss75
    v_lshlrev_b32 v20, 3, v2
    v_add_u32 v21, 151552, v20
    s_mov_b64 exec, 0xff
    ds_read_b64 v[16:17], v21
    s_waitcnt lgkmcnt(0)
    buffer_store_dwordx2 v[16:17], v20, s[60:63], s73 offen sc1
    s_mov_b64 exec, -1
L_ss75:
    ds_read_u16_d16_hi v62, v80 offset:0
    ds_read_u16_d16_hi v63, v80 offset:256
    ds_read_u16_d16_hi v64, v80 offset:512
    ds_read_u16_d16_hi v65, v80 offset:768
    ds_read_u16_d16_hi v66, v80 offset:1024
    ds_read_u16_d16_hi v67, v80 offset:1280
    ds_read_u16_d16_hi v71, v80 offset:1536
    ds_read_u16_d16_hi v72, v80 offset:1792
    ds_read_u16_d16_hi v73, v80 offset:2048
    ds_read_u16_d16_hi v74, v80 offset:2304
    ds_read_u16_d16_hi v75, v80 offset:2560
    ds_read_u16_d16_hi v76, v80 offset:2816
    s_mov_b32 s84, 1069066811
    s_and_b32 s85, s64, 1
    s_lshl_b32 s85, s85, 8
    s_waitcnt lgkmcnt(6)
    v_mul_f32 v16, s84, v62
    v_mul_f32 v17, s84, v63
    v_mul_f32 v18, s84, v64
    v_mul_f32 v68, s84, v68
    v_mul_f32 v69, s84, v69
    v_mul_f32 v70, s84, v70
    v_exp_f32 v16, v16
    v_exp_f32 v17, v17
    v_exp_f32 v18, v18
    v_exp_f32 v68, v68
    v_exp_f32 v69, v69
    v_exp_f32_e64 v70, v70
    v_cvt_pk_bf16_f32 v16, v16, v16
    v_cvt_pk_bf16_f32 v17, v17, v17
    v_cvt_pk_bf16_f32 v18, v18, v18
    v_cvt_pk_bf16_f32 v68, v68, v68
    v_cvt_pk_bf16_f32 v69, v69, v69
    v_cvt_pk_bf16_f32 v70, v70, v70
    v_and_b32 v16, 0xffff0000, v16
    v_and_b32 v17, 0xffff0000, v17
    v_and_b32 v18, 0xffff0000, v18
    v_and_b32 v68, 0xffff0000, v68
    v_and_b32 v69, 0xffff0000, v69
    v_and_b32 v70, 0xffff0000, v70
    v_mul_f32 v16, v16, v68
    v_mul_f32 v17, v17, v69
    v_mul_f32 v18, v18, v70
    v_mul_f32 v19, v65, v68
    v_mul_f32 v20, v66, v69
    v_mul_f32 v21, v67, v70
    v_mul_f32 v16, 3216550459, v16
    v_mul_f32 v17, 3216550459, v17
    v_mul_f32 v18, 3216550459, v18
    v_mul_f32 v19, 0.15915494, v19
    v_mul_f32 v20, 0.15915494, v20
    v_mul_f32 v21, 0.15915494, v21
    s_waitcnt lgkmcnt(0)
    s_add_u32 m0, s85, 50688
    v_add_f32 v68, v68, v68
    v_add_f32 v69, v69, v69
    v_add_f32 v70, v70, v70
    v_mul_f32 v38, v71, v68
    v_mul_f32 v40, v72, v69
    v_mul_f32 v42, v73, v70
    v_mul_f32 v39, v74, v68
    v_mul_f32 v41, v75, v69
    v_mul_f32 v43, v76, v70
    s_cmp_ge_u32 s64, 6
    s_cbranch_scc1 L_hb7
    v_mul_f32 v50, 1.0, v16
    v_mul_f32 v52, 1.0, v17
    v_mul_f32 v54, 1.0, v18
    v_mul_f32 v51, 1.0, v19
    v_mul_f32 v53, 1.0, v20
    v_mul_f32 v55, 1.0, v21
    v_exp_f32 v50, v50
    v_exp_f32 v52, v52
    v_exp_f32 v54, v54
    v_fract_f32 v51, v51
    v_fract_f32 v53, v53
    v_fract_f32 v55, v55
    v_cos_f32 v32, v51
    v_cos_f32 v34, v53
    v_cos_f32 v36, v55
    v_sin_f32 v33, v51
    v_sin_f32 v35, v53
    v_sin_f32_e64 v37, v55
    v_pk_mul_f32 v[32:33], v[32:33], v[50:51] op_sel:[0,0] op_sel_hi:[1,0]
    v_pk_mul_f32 v[34:35], v[34:35], v[52:53] op_sel:[0,0] op_sel_hi:[1,0]
    v_pk_mul_f32 v[36:37], v[36:37], v[54:55] op_sel:[0,0] op_sel_hi:[1,0]
    v_mul_f32 v50, 0x43800000, v16
    v_mul_f32 v52, 0x43800000, v17
    v_mul_f32 v54, 0x43800000, v18
    v_mul_f32 v51, 0x43800000, v19
    v_mul_f32 v53, 0x43800000, v20
    v_mul_f32 v55, 0x43800000, v21
    v_exp_f32 v50, v50
    v_exp_f32 v52, v52
    v_exp_f32 v54, v54
    v_fract_f32 v51, v51
    v_fract_f32 v53, v53
    v_fract_f32 v55, v55
    v_cos_f32 v44, v51
    v_cos_f32 v46, v53
    v_cos_f32 v48, v55
    v_sin_f32 v45, v51
    v_sin_f32 v47, v53
    v_sin_f32 v49, v55
    v_pk_mul_f32 v[44:45], v[44:45], v[50:51] op_sel:[0,0] op_sel_hi:[1,0]
    v_pk_mul_f32 v[46:47], v[46:47], v[52:53] op_sel:[0,0] op_sel_hi:[1,0]
    v_pk_mul_f32 v[48:49], v[48:49], v[54:55] op_sel:[0,0] op_sel_hi:[1,0]
    v_pk_mul_f32 v[50:51], v[44:45], v[38:39] op_sel:[0,0] op_sel_hi:[1,0]
    v_pk_mul_f32 v[52:53], v[46:47], v[40:41] op_sel:[0,0] op_sel_hi:[1,0]
    v_pk_mul_f32 v[54:55], v[48:49], v[42:43] op_sel:[0,0] op_sel_hi:[1,0]
    v_pk_fma_f32 v[44:45], v[44:45], v[38:39], v[50:51] op_sel:[1,1,0] op_sel_hi:[0,1,1] neg_lo:[1,0,0]
    v_pk_fma_f32 v[46:47], v[46:47], v[40:41], v[52:53] op_sel:[1,1,0] op_sel_hi:[0,1,1] neg_lo:[1,0,0]
    v_pk_fma_f32 v[48:49], v[48:49], v[42:43], v[54:55] op_sel:[1,1,0] op_sel_hi:[0,1,1] neg_lo:[1,0,0]
    v_cvt_pk_bf16_f32 v22, v38, -v39
    v_cvt_pk_bf16_f32 v23, v40, -v41
    v_cvt_pk_bf16_f32 v24, v42, -v43
    ds_write_addtid_b32 v22 offset:0
    ds_write_addtid_b32 v23 offset:10032
    ds_write_addtid_b32 v24 offset:20064
    v_pk_mul_f32 v[50:51], v[38:39], v[32:33] op_sel:[0,0] op_sel_hi:[1,0]
    v_pk_mul_f32 v[52:53], v[40:41], v[34:35] op_sel:[0,0] op_sel_hi:[1,0]
    v_pk_mul_f32 v[54:55], v[42:43], v[36:37] op_sel:[0,0] op_sel_hi:[1,0]
    v_pk_fma_f32 v[38:39], v[38:39], v[32:33], v[50:51] op_sel:[1,1,0] op_sel_hi:[0,1,1] neg_lo:[1,0,0]
    v_pk_fma_f32 v[40:41], v[40:41], v[34:35], v[52:53] op_sel:[1,1,0] op_sel_hi:[0,1,1] neg_lo:[1,0,0]
    v_pk_fma_f32 v[42:43], v[42:43], v[36:37], v[54:55] op_sel:[1,1,0] op_sel_hi:[0,1,1] neg_lo:[1,0,0]
    v_cvt_pk_bf16_f32 v22, v38, -v39
    v_cvt_pk_bf16_f32 v23, v40, -v41
    v_cvt_pk_bf16_f32 v24, v42, -v43
    ds_write_addtid_b32 v22 offset:528
    ds_write_addtid_b32 v23 offset:10560
    ds_write_addtid_b32 v24 offset:20592
    v_pk_mul_f32 v[50:51], v[38:39], v[32:33] op_sel:[0,0] op_sel_hi:[1,0]
    v_pk_mul_f32 v[52:53], v[40:41], v[34:35] op_sel:[0,0] op_sel_hi:[1,0]
    v_pk_mul_f32 v[54:55], v[42:43], v[36:37] op_sel:[0,0] op_sel_hi:[1,0]
    v_pk_fma_f32 v[38:39], v[38:39], v[32:33], v[50:51] op_sel:[1,1,0] op_sel_hi:[0,1,1] neg_lo:[1,0,0]
    v_pk_fma_f32 v[40:41], v[40:41], v[34:35], v[52:53] op_sel:[1,1,0] op_sel_hi:[0,1,1] neg_lo:[1,0,0]
    v_pk_fma_f32 v[42:43], v[42:43], v[36:37], v[54:55] op_sel:[1,1,0] op_sel_hi:[0,1,1] neg_lo:[1,0,0]
    v_cvt_pk_bf16_f32 v22, v38, -v39
    v_cvt_pk_bf16_f32 v23, v40, -v41
    v_cvt_pk_bf16_f32 v24, v42, -v43
    ds_write_addtid_b32 v22 offset:1056
    ds_write_addtid_b32 v23 offset:11088
    ds_write_addtid_b32 v24 offset:21120
    v_pk_mul_f32 v[50:51], v[38:39], v[32:33] op_sel:[0,0] op_sel_hi:[1,0]
    v_pk_mul_f32 v[52:53], v[40:41], v[34:35] op_sel:[0,0] op_sel_hi:[1,0]
    v_pk_mul_f32 v[54:55], v[42:43], v[36:37] op_sel:[0,0] op_sel_hi:[1,0]
    v_pk_fma_f32 v[38:39], v[38:39], v[32:33], v[50:51] op_sel:[1,1,0] op_sel_hi:[0,1,1] neg_lo:[1,0,0]
    v_pk_fma_f32 v[40:41], v[40:41], v[34:35], v[52:53] op_sel:[1,1,0] op_sel_hi:[0,1,1] neg_lo:[1,0,0]
    v_pk_fma_f32 v[42:43], v[42:43], v[36:37], v[54:55] op_sel:[1,1,0] op_sel_hi:[0,1,1] neg_lo:[1,0,0]
    v_cvt_pk_bf16_f32 v22, v38, -v39
    v_cvt_pk_bf16_f32 v23, v40, -v41
    v_cvt_pk_bf16_f32 v24, v42, -v43
    ds_write_addtid_b32 v22 offset:1584
    ds_write_addtid_b32 v23 offset:11616
    ds_write_addtid_b32 v24 offset:21648
    v_pk_mul_f32 v[50:51], v[38:39], v[32:33] op_sel:[0,0] op_sel_hi:[1,0]
    v_pk_mul_f32 v[52:53], v[40:41], v[34:35] op_sel:[0,0] op_sel_hi:[1,0]
    v_pk_mul_f32 v[54:55], v[42:43], v[36:37] op_sel:[0,0] op_sel_hi:[1,0]
    v_pk_fma_f32 v[38:39], v[38:39], v[32:33], v[50:51] op_sel:[1,1,0] op_sel_hi:[0,1,1] neg_lo:[1,0,0]
    v_pk_fma_f32 v[40:41], v[40:41], v[34:35], v[52:53] op_sel:[1,1,0] op_sel_hi:[0,1,1] neg_lo:[1,0,0]
    v_pk_fma_f32 v[42:43], v[42:43], v[36:37], v[54:55] op_sel:[1,1,0] op_sel_hi:[0,1,1] neg_lo:[1,0,0]
    v_cvt_pk_bf16_f32 v22, v38, -v39
    v_cvt_pk_bf16_f32 v23, v40, -v41
    v_cvt_pk_bf16_f32 v24, v42, -v43
    ds_write_addtid_b32 v22 offset:2112
    ds_write_addtid_b32 v23 offset:12144
    ds_write_addtid_b32 v24 offset:22176
    v_pk_mul_f32 v[50:51], v[38:39], v[32:33] op_sel:[0,0] op_sel_hi:[1,0]
    v_pk_mul_f32 v[52:53], v[40:41], v[34:35] op_sel:[0,0] op_sel_hi:[1,0]
    v_pk_mul_f32 v[54:55], v[42:43], v[36:37] op_sel:[0,0] op_sel_hi:[1,0]
    v_pk_fma_f32 v[38:39], v[38:39], v[32:33], v[50:51] op_sel:[1,1,0] op_sel_hi:[0,1,1] neg_lo:[1,0,0]
    v_pk_fma_f32 v[40:41], v[40:41], v[34:35], v[52:53] op_sel:[1,1,0] op_sel_hi:[0,1,1] neg_lo:[1,0,0]
    v_pk_fma_f32 v[42:43], v[42:43], v[36:37], v[54:55] op_sel:[1,1,0] op_sel_hi:[0,1,1] neg_lo:[1,0,0]
    v_cvt_pk_bf16_f32 v22, v38, -v39
    v_cvt_pk_bf16_f32 v23, v40, -v41
    v_cvt_pk_bf16_f32 v24, v42, -v43
    ds_write_addtid_b32 v22 offset:2640
    ds_write_addtid_b32 v23 offset:12672
    ds_write_addtid_b32 v24 offset:22704
    v_pk_mul_f32 v[50:51], v[38:39], v[32:33] op_sel:[0,0] op_sel_hi:[1,0]
    v_pk_mul_f32 v[52:53], v[40:41], v[34:35] op_sel:[0,0] op_sel_hi:[1,0]
    v_pk_mul_f32 v[54:55], v[42:43], v[36:37] op_sel:[0,0] op_sel_hi:[1,0]
    v_pk_fma_f32 v[38:39], v[38:39], v[32:33], v[50:51] op_sel:[1,1,0] op_sel_hi:[0,1,1] neg_lo:[1,0,0]
    v_pk_fma_f32 v[40:41], v[40:41], v[34:35], v[52:53] op_sel:[1,1,0] op_sel_hi:[0,1,1] neg_lo:[1,0,0]
    v_pk_fma_f32 v[42:43], v[42:43], v[36:37], v[54:55] op_sel:[1,1,0] op_sel_hi:[0,1,1] neg_lo:[1,0,0]
    v_cvt_pk_bf16_f32 v22, v38, -v39
    v_cvt_pk_bf16_f32 v23, v40, -v41
    v_cvt_pk_bf16_f32 v24, v42, -v43
    ds_write_addtid_b32 v22 offset:3168
    ds_write_addtid_b32 v23 offset:13200
    ds_write_addtid_b32 v24 offset:23232
    v_pk_mul_f32 v[50:51], v[38:39], v[32:33] op_sel:[0,0] op_sel_hi:[1,0]
    v_pk_mul_f32 v[52:53], v[40:41], v[34:35] op_sel:[0,0] op_sel_hi:[1,0]
    v_pk_mul_f32 v[54:55], v[42:43], v[36:37] op_sel:[0,0] op_sel_hi:[1,0]
    v_pk_fma_f32 v[38:39], v[38:39], v[32:33], v[50:51] op_sel:[1,1,0] op_sel_hi:[0,1,1] neg_lo:[1,0,0]
    v_pk_fma_f32 v[40:41], v[40:41], v[34:35], v[52:53] op_sel:[1,1,0] op_sel_hi:[0,1,1] neg_lo:[1,0,0]
    v_pk_fma_f32 v[42:43], v[42:43], v[36:37], v[54:55] op_sel:[1,1,0] op_sel_hi:[0,1,1] neg_lo:[1,0,0]
    v_cvt_pk_bf16_f32 v22, v38, -v39
    v_cvt_pk_bf16_f32 v23, v40, -v41
    v_cvt_pk_bf16_f32 v24, v42, -v43
    ds_write_addtid_b32 v22 offset:3696
    ds_write_addtid_b32 v23 offset:13728
    ds_write_addtid_b32 v24 offset:23760
    v_pk_mul_f32 v[50:51], v[32:33], v[32:33] op_sel:[0,0] op_sel_hi:[1,0]
    v_pk_mul_f32 v[52:53], v[34:35], v[34:35] op_sel:[0,0] op_sel_hi:[1,0]
    v_pk_mul_f32 v[54:55], v[36:37], v[36:37] op_sel:[0,0] op_sel_hi:[1,0]
    v_pk_fma_f32 v[32:33], v[32:33], v[32:33], v[50:51] op_sel:[1,1,0] op_sel_hi:[0,1,1] neg_lo:[1,0,0]
    v_pk_fma_f32 v[34:35], v[34:35], v[34:35], v[52:53] op_sel:[1,1,0] op_sel_hi:[0,1,1] neg_lo:[1,0,0]
    v_pk_fma_f32 v[36:37], v[36:37], v[36:37], v[54:55] op_sel:[1,1,0] op_sel_hi:[0,1,1] neg_lo:[1,0,0]
    v_cvt_pk_bf16_f32 v22, v44, -v45
    v_cvt_pk_bf16_f32 v23, v46, -v47
    v_cvt_pk_bf16_f32 v24, v48, -v49
    ds_write_addtid_b32 v22 offset:4224
    ds_write_addtid_b32 v23 offset:14256
    ds_write_addtid_b32 v24 offset:24288
    v_pk_mul_f32 v[50:51], v[44:45], v[32:33] op_sel:[0,0] op_sel_hi:[1,0]
    v_pk_mul_f32 v[52:53], v[46:47], v[34:35] op_sel:[0,0] op_sel_hi:[1,0]
    v_pk_mul_f32 v[54:55], v[48:49], v[36:37] op_sel:[0,0] op_sel_hi:[1,0]
    v_pk_fma_f32 v[44:45], v[44:45], v[32:33], v[50:51] op_sel:[1,1,0] op_sel_hi:[0,1,1] neg_lo:[1,0,0]
    v_pk_fma_f32 v[46:47], v[46:47], v[34:35], v[52:53] op_sel:[1,1,0] op_sel_hi:[0,1,1] neg_lo:[1,0,0]
    v_pk_fma_f32 v[48:49], v[48:49], v[36:37], v[54:55] op_sel:[1,1,0] op_sel_hi:[0,1,1] neg_lo:[1,0,0]
    v_cvt_pk_bf16_f32 v22, v44, -v45
    v_cvt_pk_bf16_f32 v23, v46, -v47
    v_cvt_pk_bf16_f32 v24, v48, -v49
    ds_write_addtid_b32 v22 offset:4752
    ds_write_addtid_b32 v23 offset:14784
    ds_write_addtid_b32 v24 offset:24816
    v_pk_mul_f32 v[50:51], v[44:45], v[32:33] op_sel:[0,0] op_sel_hi:[1,0]
    v_pk_mul_f32 v[52:53], v[46:47], v[34:35] op_sel:[0,0] op_sel_hi:[1,0]
    v_pk_mul_f32 v[54:55], v[48:49], v[36:37] op_sel:[0,0] op_sel_hi:[1,0]
    v_pk_fma_f32 v[44:45], v[44:45], v[32:33], v[50:51] op_sel:[1,1,0] op_sel_hi:[0,1,1] neg_lo:[1,0,0]
    v_pk_fma_f32 v[46:47], v[46:47], v[34:35], v[52:53] op_sel:[1,1,0] op_sel_hi:[0,1,1] neg_lo:[1,0,0]
    v_pk_fma_f32 v[48:49], v[48:49], v[36:37], v[54:55] op_sel:[1,1,0] op_sel_hi:[0,1,1] neg_lo:[1,0,0]
    v_cvt_pk_bf16_f32 v22, v44, -v45
    v_cvt_pk_bf16_f32 v23, v46, -v47
    v_cvt_pk_bf16_f32 v24, v48, -v49
    ds_write_addtid_b32 v22 offset:5280
    ds_write_addtid_b32 v23 offset:15312
    ds_write_addtid_b32 v24 offset:25344
    v_pk_mul_f32 v[50:51], v[44:45], v[32:33] op_sel:[0,0] op_sel_hi:[1,0]
    v_pk_mul_f32 v[52:53], v[46:47], v[34:35] op_sel:[0,0] op_sel_hi:[1,0]
    v_pk_mul_f32 v[54:55], v[48:49], v[36:37] op_sel:[0,0] op_sel_hi:[1,0]
    v_pk_fma_f32 v[44:45], v[44:45], v[32:33], v[50:51] op_sel:[1,1,0] op_sel_hi:[0,1,1] neg_lo:[1,0,0]
    v_pk_fma_f32 v[46:47], v[46:47], v[34:35], v[52:53] op_sel:[1,1,0] op_sel_hi:[0,1,1] neg_lo:[1,0,0]
    v_pk_fma_f32 v[48:49], v[48:49], v[36:37], v[54:55] op_sel:[1,1,0] op_sel_hi:[0,1,1] neg_lo:[1,0,0]
    v_cvt_pk_bf16_f32 v22, v44, -v45
    v_cvt_pk_bf16_f32 v23, v46, -v47
    v_cvt_pk_bf16_f32 v24, v48, -v49
    ds_write_addtid_b32 v22 offset:5808
    ds_write_addtid_b32 v23 offset:15840
    ds_write_addtid_b32 v24 offset:25872
    v_pk_mul_f32 v[50:51], v[44:45], v[32:33] op_sel:[0,0] op_sel_hi:[1,0]
    v_pk_mul_f32 v[52:53], v[46:47], v[34:35] op_sel:[0,0] op_sel_hi:[1,0]
    v_pk_mul_f32 v[54:55], v[48:49], v[36:37] op_sel:[0,0] op_sel_hi:[1,0]
    v_pk_fma_f32 v[44:45], v[44:45], v[32:33], v[50:51] op_sel:[1,1,0] op_sel_hi:[0,1,1] neg_lo:[1,0,0]
    v_pk_fma_f32 v[46:47], v[46:47], v[34:35], v[52:53] op_sel:[1,1,0] op_sel_hi:[0,1,1] neg_lo:[1,0,0]
    v_pk_fma_f32 v[48:49], v[48:49], v[36:37], v[54:55] op_sel:[1,1,0] op_sel_hi:[0,1,1] neg_lo:[1,0,0]
    v_cvt_pk_bf16_f32 v22, v44, -v45
    v_cvt_pk_bf16_f32 v23, v46, -v47
    v_cvt_pk_bf16_f32 v24, v48, -v49
    ds_write_addtid_b32 v22 offset:6336
    ds_write_addtid_b32 v23 offset:16368
    ds_write_addtid_b32 v24 offset:26400
    s_branch L_hd8
L_hb7:
    v_mul_f32 v50, 4.0, v16
    v_mul_f32 v52, 4.0, v17
    v_mul_f32 v54, 4.0, v18
    v_mul_f32 v51, 4.0, v19
    v_mul_f32 v53, 4.0, v20
    v_mul_f32 v55, 4.0, v21
    v_exp_f32 v50, v50
    v_exp_f32 v52, v52
    v_exp_f32 v54, v54
    v_fract_f32 v51, v51
    v_fract_f32 v53, v53
    v_fract_f32 v55, v55
    v_cos_f32 v32, v51
    v_cos_f32 v34, v53
    v_cos_f32 v36, v55
    v_sin_f32 v33, v51
    v_sin_f32 v35, v53
    v_sin_f32_e64 v37, v55
    v_pk_mul_f32 v[32:33], v[32:33], v[50:51] op_sel:[0,0] op_sel_hi:[1,0]
    v_pk_mul_f32 v[34:35], v[34:35], v[52:53] op_sel:[0,0] op_sel_hi:[1,0]
    v_pk_mul_f32 v[36:37], v[36:37], v[54:55] op_sel:[0,0] op_sel_hi:[1,0]
    v_mul_f32 v50, 0x43800000, v16
    v_mul_f32 v52, 0x43800000, v17
    v_mul_f32 v54, 0x43800000, v18
    v_mul_f32 v51, 0x43800000, v19
    v_mul_f32 v53, 0x43800000, v20
    v_mul_f32 v55, 0x43800000, v21
    v_exp_f32 v50, v50
    v_exp_f32 v52, v52
    v_exp_f32 v54, v54
    v_fract_f32 v51, v51
    v_fract_f32 v53, v53
    v_fract_f32 v55, v55
    v_cos_f32 v44, v51
    v_cos_f32 v46, v53
    v_cos_f32 v48, v55
    v_sin_f32 v45, v51
    v_sin_f32 v47, v53
    v_sin_f32 v49, v55
    v_pk_mul_f32 v[44:45], v[44:45], v[50:51] op_sel:[0,0] op_sel_hi:[1,0]
    v_pk_mul_f32 v[46:47], v[46:47], v[52:53] op_sel:[0,0] op_sel_hi:[1,0]
    v_pk_mul_f32 v[48:49], v[48:49], v[54:55] op_sel:[0,0] op_sel_hi:[1,0]
    v_mul_f32 v50, 0x44000000, v16
    v_mul_f32 v52, 0x44000000, v17
    v_mul_f32 v54, 0x44000000, v18
    v_mul_f32 v51, 0x44000000, v19
    v_mul_f32 v53, 0x44000000, v20
    v_mul_f32 v55, 0x44000000, v21
    v_exp_f32 v50, v50
    v_exp_f32 v52, v52
    v_exp_f32 v54, v54
    v_fract_f32 v51, v51
    v_fract_f32 v53, v53
    v_fract_f32 v55, v55
    v_cos_f32 v26, v51
    v_cos_f32 v28, v53
    v_cos_f32 v30, v55
    v_sin_f32 v27, v51
    v_sin_f32 v29, v53
    v_sin_f32 v31, v55
    v_pk_mul_f32 v[26:27], v[26:27], v[50:51] op_sel:[0,0] op_sel_hi:[1,0]
    v_pk_mul_f32 v[28:29], v[28:29], v[52:53] op_sel:[0,0] op_sel_hi:[1,0]
    v_pk_mul_f32 v[30:31], v[30:31], v[54:55] op_sel:[0,0] op_sel_hi:[1,0]
    v_pk_mul_f32 v[50:51], v[26:27], v[38:39] op_sel:[0,0] op_sel_hi:[1,0]
    v_pk_mul_f32 v[52:53], v[28:29], v[40:41] op_sel:[0,0] op_sel_hi:[1,0]
    v_pk_mul_f32 v[54:55], v[30:31], v[42:43] op_sel:[0,0] op_sel_hi:[1,0]
    v_pk_fma_f32 v[26:27], v[26:27], v[38:39], v[50:51] op_sel:[1,1,0] op_sel_hi:[0,1,1] neg_lo:[1,0,0]
    v_pk_fma_f32 v[28:29], v[28:29], v[40:41], v[52:53] op_sel:[1,1,0] op_sel_hi:[0,1,1] neg_lo:[1,0,0]
    v_pk_fma_f32 v[30:31], v[30:31], v[42:43], v[54:55] op_sel:[1,1,0] op_sel_hi:[0,1,1] neg_lo:[1,0,0]
    v_pk_mul_f32 v[50:51], v[32:33], v[32:33] op_sel:[0,0] op_sel_hi:[1,0]
    v_pk_mul_f32 v[52:53], v[34:35], v[34:35] op_sel:[0,0] op_sel_hi:[1,0]
    v_pk_mul_f32 v[54:55], v[36:37], v[36:37] op_sel:[0,0] op_sel_hi:[1,0]
    v_pk_fma_f32 v[56:57], v[32:33], v[32:33], v[50:51] op_sel:[1,1,0] op_sel_hi:[0,1,1] neg_lo:[1,0,0]
    v_pk_fma_f32 v[58:59], v[34:35], v[34:35], v[52:53] op_sel:[1,1,0] op_sel_hi:[0,1,1] neg_lo:[1,0,0]
    v_pk_fma_f32 v[60:61], v[36:37], v[36:37], v[54:55] op_sel:[1,1,0] op_sel_hi:[0,1,1] neg_lo:[1,0,0]
    v_cvt_pk_bf16_f32 v22, v26, -v27
    v_cvt_pk_bf16_f32 v23, v28, -v29
    v_cvt_pk_bf16_f32 v24, v30, -v31
    ds_write_addtid_b32 v22 offset:6864
    ds_write_addtid_b32 v23 offset:16896
    ds_write_addtid_b32 v24 offset:26928
    v_pk_mul_f32 v[50:51], v[26:27], v[32:33] op_sel:[0,0] op_sel_hi:[1,0]
    v_pk_mul_f32 v[52:53], v[28:29], v[34:35] op_sel:[0,0] op_sel_hi:[1,0]
    v_pk_mul_f32 v[54:55], v[30:31], v[36:37] op_sel:[0,0] op_sel_hi:[1,0]
    v_pk_fma_f32 v[38:39], v[26:27], v[32:33], v[50:51] op_sel:[1,1,0] op_sel_hi:[0,1,1] neg_lo:[1,0,0]
    v_pk_fma_f32 v[40:41], v[28:29], v[34:35], v[52:53] op_sel:[1,1,0] op_sel_hi:[0,1,1] neg_lo:[1,0,0]
    v_pk_fma_f32 v[42:43], v[30:31], v[36:37], v[54:55] op_sel:[1,1,0] op_sel_hi:[0,1,1] neg_lo:[1,0,0]
    v_cvt_pk_bf16_f32 v22, v38, -v39
    v_cvt_pk_bf16_f32 v23, v40, -v41
    v_cvt_pk_bf16_f32 v24, v42, -v43
    ds_write_addtid_b32 v22 offset:7392
    ds_write_addtid_b32 v23 offset:17424
    ds_write_addtid_b32 v24 offset:27456
    v_pk_mul_f32 v[50:51], v[26:27], v[56:57] op_sel:[0,0] op_sel_hi:[1,0]
    v_pk_mul_f32 v[52:53], v[28:29], v[58:59] op_sel:[0,0] op_sel_hi:[1,0]
    v_pk_mul_f32 v[54:55], v[30:31], v[60:61] op_sel:[0,0] op_sel_hi:[1,0]
    v_pk_fma_f32 v[38:39], v[26:27], v[56:57], v[50:51] op_sel:[1,1,0] op_sel_hi:[0,1,1] neg_lo:[1,0,0]
    v_pk_fma_f32 v[40:41], v[28:29], v[58:59], v[52:53] op_sel:[1,1,0] op_sel_hi:[0,1,1] neg_lo:[1,0,0]
    v_pk_fma_f32 v[42:43], v[30:31], v[60:61], v[54:55] op_sel:[1,1,0] op_sel_hi:[0,1,1] neg_lo:[1,0,0]
    v_cvt_pk_bf16_f32 v22, v38, -v39
    v_cvt_pk_bf16_f32 v23, v40, -v41
    v_cvt_pk_bf16_f32 v24, v42, -v43
    ds_write_addtid_b32 v22 offset:7920
    ds_write_addtid_b32 v23 offset:17952
    ds_write_addtid_b32 v24 offset:27984
    v_pk_mul_f32 v[50:51], v[26:27], v[44:45] op_sel:[0,0] op_sel_hi:[1,0]
    v_pk_mul_f32 v[52:53], v[28:29], v[46:47] op_sel:[0,0] op_sel_hi:[1,0]
    v_pk_mul_f32 v[54:55], v[30:31], v[48:49] op_sel:[0,0] op_sel_hi:[1,0]
    v_pk_fma_f32 v[26:27], v[26:27], v[44:45], v[50:51] op_sel:[1,1,0] op_sel_hi:[0,1,1] neg_lo:[1,0,0]
    v_pk_fma_f32 v[28:29], v[28:29], v[46:47], v[52:53] op_sel:[1,1,0] op_sel_hi:[0,1,1] neg_lo:[1,0,0]
    v_pk_fma_f32 v[30:31], v[30:31], v[48:49], v[54:55] op_sel:[1,1,0] op_sel_hi:[0,1,1] neg_lo:[1,0,0]
    v_cvt_pk_bf16_f32 v22, v26, -v27
    v_cvt_pk_bf16_f32 v23, v28, -v29
    v_cvt_pk_bf16_f32 v24, v30, -v31
    ds_write_addtid_b32 v22 offset:8448
    ds_write_addtid_b32 v23 offset:18480
    ds_write_addtid_b32 v24 offset:28512
    v_pk_mul_f32 v[50:51], v[26:27], v[32:33] op_sel:[0,0] op_sel_hi:[1,0]
    v_pk_mul_f32 v[52:53], v[28:29], v[34:35] op_sel:[0,0] op_sel_hi:[1,0]
    v_pk_mul_f32 v[54:55], v[30:31], v[36:37] op_sel:[0,0] op_sel_hi:[1,0]
    v_pk_fma_f32 v[38:39], v[26:27], v[32:33], v[50:51] op_sel:[1,1,0] op_sel_hi:[0,1,1] neg_lo:[1,0,0]
    v_pk_fma_f32 v[40:41], v[28:29], v[34:35], v[52:53] op_sel:[1,1,0] op_sel_hi:[0,1,1] neg_lo:[1,0,0]
    v_pk_fma_f32 v[42:43], v[30:31], v[36:37], v[54:55] op_sel:[1,1,0] op_sel_hi:[0,1,1] neg_lo:[1,0,0]
    v_cvt_pk_bf16_f32 v22, v38, -v39
    v_cvt_pk_bf16_f32 v23, v40, -v41
    v_cvt_pk_bf16_f32 v24, v42, -v43
    ds_write_addtid_b32 v22 offset:8976
    ds_write_addtid_b32 v23 offset:19008
    ds_write_addtid_b32 v24 offset:29040
    v_pk_mul_f32 v[50:51], v[26:27], v[56:57] op_sel:[0,0] op_sel_hi:[1,0]
    v_pk_mul_f32 v[52:53], v[28:29], v[58:59] op_sel:[0,0] op_sel_hi:[1,0]
    v_pk_mul_f32 v[54:55], v[30:31], v[60:61] op_sel:[0,0] op_sel_hi:[1,0]
    v_pk_fma_f32 v[38:39], v[26:27], v[56:57], v[50:51] op_sel:[1,1,0] op_sel_hi:[0,1,1] neg_lo:[1,0,0]
    v_pk_fma_f32 v[40:41], v[28:29], v[58:59], v[52:53] op_sel:[1,1,0] op_sel_hi:[0,1,1] neg_lo:[1,0,0]
    v_pk_fma_f32 v[42:43], v[30:31], v[60:61], v[54:55] op_sel:[1,1,0] op_sel_hi:[0,1,1] neg_lo:[1,0,0]
    v_cvt_pk_bf16_f32 v22, v38, -v39
    v_cvt_pk_bf16_f32 v23, v40, -v41
    v_cvt_pk_bf16_f32 v24, v42, -v43
    ds_write_addtid_b32 v22 offset:9504
    ds_write_addtid_b32 v23 offset:19536
    ds_write_addtid_b32 v24 offset:29568
    s_add_u32 m0, s85, 61440
    v_pk_mul_f32 v[50:51], v[26:27], v[44:45] op_sel:[0,0] op_sel_hi:[1,0]
    v_pk_mul_f32 v[52:53], v[28:29], v[46:47] op_sel:[0,0] op_sel_hi:[1,0]
    v_pk_mul_f32 v[54:55], v[30:31], v[48:49] op_sel:[0,0] op_sel_hi:[1,0]
    v_pk_fma_f32 v[26:27], v[26:27], v[44:45], v[50:51] op_sel:[1,1,0] op_sel_hi:[0,1,1] neg_lo:[1,0,0]
    v_pk_fma_f32 v[28:29], v[28:29], v[46:47], v[52:53] op_sel:[1,1,0] op_sel_hi:[0,1,1] neg_lo:[1,0,0]
    v_pk_fma_f32 v[30:31], v[30:31], v[48:49], v[54:55] op_sel:[1,1,0] op_sel_hi:[0,1,1] neg_lo:[1,0,0]
    v_cvt_pk_bf16_f32 v22, v26, -v27
    v_cvt_pk_bf16_f32 v23, v28, -v29
    v_cvt_pk_bf16_f32 v24, v30, -v31
    ds_write_addtid_b32 v22 offset:52864
    ds_write_addtid_b32 v23 offset:57088
    ds_write_addtid_b32 v24 offset:61312
    v_pk_mul_f32 v[50:51], v[26:27], v[56:57] op_sel:[0,0] op_sel_hi:[1,0]
    v_pk_mul_f32 v[52:53], v[28:29], v[58:59] op_sel:[0,0] op_sel_hi:[1,0]
    v_pk_mul_f32 v[54:55], v[30:31], v[60:61] op_sel:[0,0] op_sel_hi:[1,0]
    v_pk_fma_f32 v[38:39], v[26:27], v[56:57], v[50:51] op_sel:[1,1,0] op_sel_hi:[0,1,1] neg_lo:[1,0,0]
    v_pk_fma_f32 v[40:41], v[28:29], v[58:59], v[52:53] op_sel:[1,1,0] op_sel_hi:[0,1,1] neg_lo:[1,0,0]
    v_pk_fma_f32 v[42:43], v[30:31], v[60:61], v[54:55] op_sel:[1,1,0] op_sel_hi:[0,1,1] neg_lo:[1,0,0]
    v_cvt_pk_bf16_f32 v22, v38, -v39
    v_cvt_pk_bf16_f32 v23, v40, -v41
    v_cvt_pk_bf16_f32 v24, v42, -v43
    ds_write_addtid_b32 v22 offset:53392
    ds_write_addtid_b32 v23 offset:57616
    ds_write_addtid_b32 v24 offset:61840
    v_pk_mul_f32 v[50:51], v[26:27], v[44:45] op_sel:[0,0] op_sel_hi:[1,0]
    v_pk_mul_f32 v[52:53], v[28:29], v[46:47] op_sel:[0,0] op_sel_hi:[1,0]
    v_pk_mul_f32 v[54:55], v[30:31], v[48:49] op_sel:[0,0] op_sel_hi:[1,0]
    v_pk_fma_f32 v[26:27], v[26:27], v[44:45], v[50:51] op_sel:[1,1,0] op_sel_hi:[0,1,1] neg_lo:[1,0,0]
    v_pk_fma_f32 v[28:29], v[28:29], v[46:47], v[52:53] op_sel:[1,1,0] op_sel_hi:[0,1,1] neg_lo:[1,0,0]
    v_pk_fma_f32 v[30:31], v[30:31], v[48:49], v[54:55] op_sel:[1,1,0] op_sel_hi:[0,1,1] neg_lo:[1,0,0]
    v_cvt_pk_bf16_f32 v22, v26, -v27
    v_cvt_pk_bf16_f32 v23, v28, -v29
    v_cvt_pk_bf16_f32 v24, v30, -v31
    ds_write_addtid_b32 v22 offset:53920
    ds_write_addtid_b32 v23 offset:58144
    ds_write_addtid_b32 v24 offset:62368
    v_pk_mul_f32 v[50:51], v[26:27], v[56:57] op_sel:[0,0] op_sel_hi:[1,0]
    v_pk_mul_f32 v[52:53], v[28:29], v[58:59] op_sel:[0,0] op_sel_hi:[1,0]
    v_pk_mul_f32 v[54:55], v[30:31], v[60:61] op_sel:[0,0] op_sel_hi:[1,0]
    v_pk_fma_f32 v[38:39], v[26:27], v[56:57], v[50:51] op_sel:[1,1,0] op_sel_hi:[0,1,1] neg_lo:[1,0,0]
    v_pk_fma_f32 v[40:41], v[28:29], v[58:59], v[52:53] op_sel:[1,1,0] op_sel_hi:[0,1,1] neg_lo:[1,0,0]
    v_pk_fma_f32 v[42:43], v[30:31], v[60:61], v[54:55] op_sel:[1,1,0] op_sel_hi:[0,1,1] neg_lo:[1,0,0]
    v_cvt_pk_bf16_f32 v22, v38, -v39
    v_cvt_pk_bf16_f32 v23, v40, -v41
    v_cvt_pk_bf16_f32 v24, v42, -v43
    ds_write_addtid_b32 v22 offset:54448
    ds_write_addtid_b32 v23 offset:58672
    ds_write_addtid_b32 v24 offset:62896
    v_pk_mul_f32 v[50:51], v[26:27], v[44:45] op_sel:[0,0] op_sel_hi:[1,0]
    v_pk_mul_f32 v[52:53], v[28:29], v[46:47] op_sel:[0,0] op_sel_hi:[1,0]
    v_pk_mul_f32 v[54:55], v[30:31], v[48:49] op_sel:[0,0] op_sel_hi:[1,0]
    v_pk_fma_f32 v[26:27], v[26:27], v[44:45], v[50:51] op_sel:[1,1,0] op_sel_hi:[0,1,1] neg_lo:[1,0,0]
    v_pk_fma_f32 v[28:29], v[28:29], v[46:47], v[52:53] op_sel:[1,1,0] op_sel_hi:[0,1,1] neg_lo:[1,0,0]
    v_pk_fma_f32 v[30:31], v[30:31], v[48:49], v[54:55] op_sel:[1,1,0] op_sel_hi:[0,1,1] neg_lo:[1,0,0]
    v_cvt_pk_bf16_f32 v22, v26, -v27
    v_cvt_pk_bf16_f32 v23, v28, -v29
    v_cvt_pk_bf16_f32 v24, v30, -v31
    ds_write_addtid_b32 v22 offset:54976
    ds_write_addtid_b32 v23 offset:59200
    ds_write_addtid_b32 v24 offset:63424
    v_pk_mul_f32 v[50:51], v[26:27], v[56:57] op_sel:[0,0] op_sel_hi:[1,0]
    v_pk_mul_f32 v[52:53], v[28:29], v[58:59] op_sel:[0,0] op_sel_hi:[1,0]
    v_pk_mul_f32 v[54:55], v[30:31], v[60:61] op_sel:[0,0] op_sel_hi:[1,0]
    v_pk_fma_f32 v[38:39], v[26:27], v[56:57], v[50:51] op_sel:[1,1,0] op_sel_hi:[0,1,1] neg_lo:[1,0,0]
    v_pk_fma_f32 v[40:41], v[28:29], v[58:59], v[52:53] op_sel:[1,1,0] op_sel_hi:[0,1,1] neg_lo:[1,0,0]
    v_pk_fma_f32 v[42:43], v[30:31], v[60:61], v[54:55] op_sel:[1,1,0] op_sel_hi:[0,1,1] neg_lo:[1,0,0]
    v_cvt_pk_bf16_f32 v22, v38, -v39
    v_cvt_pk_bf16_f32 v23, v40, -v41
    v_cvt_pk_bf16_f32 v24, v42, -v43
    ds_write_addtid_b32 v22 offset:55504
    ds_write_addtid_b32 v23 offset:59728
    ds_write_addtid_b32 v24 offset:63952
    v_pk_mul_f32 v[50:51], v[26:27], v[44:45] op_sel:[0,0] op_sel_hi:[1,0]
    v_pk_mul_f32 v[52:53], v[28:29], v[46:47] op_sel:[0,0] op_sel_hi:[1,0]
    v_pk_mul_f32 v[54:55], v[30:31], v[48:49] op_sel:[0,0] op_sel_hi:[1,0]
    v_pk_fma_f32 v[26:27], v[26:27], v[44:45], v[50:51] op_sel:[1,1,0] op_sel_hi:[0,1,1] neg_lo:[1,0,0]
    v_pk_fma_f32 v[28:29], v[28:29], v[46:47], v[52:53] op_sel:[1,1,0] op_sel_hi:[0,1,1] neg_lo:[1,0,0]
    v_pk_fma_f32 v[30:31], v[30:31], v[48:49], v[54:55] op_sel:[1,1,0] op_sel_hi:[0,1,1] neg_lo:[1,0,0]
    v_cvt_pk_bf16_f32 v22, v26, -v27
    v_cvt_pk_bf16_f32 v23, v28, -v29
    v_cvt_pk_bf16_f32 v24, v30, -v31
    ds_write_addtid_b32 v22 offset:56032
    ds_write_addtid_b32 v23 offset:60256
    ds_write_addtid_b32 v24 offset:64480
    v_pk_mul_f32 v[50:51], v[26:27], v[56:57] op_sel:[0,0] op_sel_hi:[1,0]
    v_pk_mul_f32 v[52:53], v[28:29], v[58:59] op_sel:[0,0] op_sel_hi:[1,0]
    v_pk_mul_f32 v[54:55], v[30:31], v[60:61] op_sel:[0,0] op_sel_hi:[1,0]
    v_pk_fma_f32 v[38:39], v[26:27], v[56:57], v[50:51] op_sel:[1,1,0] op_sel_hi:[0,1,1] neg_lo:[1,0,0]
    v_pk_fma_f32 v[40:41], v[28:29], v[58:59], v[52:53] op_sel:[1,1,0] op_sel_hi:[0,1,1] neg_lo:[1,0,0]
    v_pk_fma_f32 v[42:43], v[30:31], v[60:61], v[54:55] op_sel:[1,1,0] op_sel_hi:[0,1,1] neg_lo:[1,0,0]
    v_cvt_pk_bf16_f32 v22, v38, -v39
    v_cvt_pk_bf16_f32 v23, v40, -v41
    v_cvt_pk_bf16_f32 v24, v42, -v43
    ds_write_addtid_b32 v22 offset:56560
    ds_write_addtid_b32 v23 offset:60784
    ds_write_addtid_b32 v24 offset:65008
L_hd8:
    s_waitcnt vmcnt(0) lgkmcnt(0)
    s_barrier
    ds_read_b128 v[32:35], v84 offset:0
    ds_read_b128 v[36:39], v85 offset:0
    ds_read_b128 v[40:43], v84 offset:32
    ds_read_b128 v[44:47], v85 offset:32
    ds_read_b128 v[48:51], v84 offset:64
    ds_read_b128 v[52:55], v85 offset:64
    ds_read_b128 v[56:59], v84 offset:96
    ds_read_b128 v[60:63], v85 offset:96
    ds_read_b128 v[64:67], v84 offset:128
    ds_read_b128 v[68:71], v85 offset:128
    s_cmp_ge_u32 s76, s65
    s_cbranch_scc1 L_kn77
    v_mov_b32_e64 v72, 0
    v_mov_b32 v73, 0
    s_mov_b32 s86, 0
    s_mov_b32 s87, -1
    s_waitcnt lgkmcnt(8)
    v_mfma_f32_32x32x16_bf16 v[16:31], v[32:35], v[36:39], 0
    ds_read_b128 v[32:35], v84 offset:160
    ds_read_b128 v[36:39], v85 offset:160
    v_and_b32_e64 v112, 1, v2
    v_bfe_u32 v113, v2, 4, 1
    v_lshrrev_b32_e64 v114, 5, v2
    v_bfe_u32 v115, v2, 2, 2
    v_bfe_u32 v116, v2, 2, 3
    v_lshl_add_u32 v117, v114, 3, v115
    s_waitcnt lgkmcnt(8)
    v_mfma_f32_32x32x16_bf16 v[16:31], v[40:43], v[44:47], v[16:31]
    ds_read_b128 v[40:43], v84 offset:192
    ds_read_b128 v[44:47], v85 offset:192
    v_and_b32 v118, 3, v2
    v_bfe_u32 v119, v2, 1, 1
    v_and_b32_e64 v121, 31, v2
    v_lshl_add_u32 v122, v114, 2, v121
    v_add_u32_e64 v122, 28, v122
    v_bfe_u32 v123, v122, 1, 3
    s_waitcnt lgkmcnt(8)
    v_mfma_f32_32x32x16_bf16 v[16:31], v[48:51], v[52:55], v[16:31]
    ds_read_b128 v[48:51], v84 offset:224
    ds_read_b128 v[52:55], v85 offset:224
    v_lshlrev_b32 v3, 7, v122
    v_lshl_add_u32 v3, v123, 4, v3
    v_add_u32 v3, 119808, v3
    v_lshl_add_u32 v122, v113, 2, v118
    v_sub_u32_e64 v122, v122, v117
    v_lshlrev_b32 v4, 3, v122
    s_waitcnt lgkmcnt(8)
    v_mfma_f32_32x32x16_bf16 v[16:31], v[56:59], v[60:63], v[16:31]
    ds_read_b128 v[56:59], v84 offset:256
    ds_read_b128 v[60:63], v85 offset:256
    v_add_u32 v4, 96, v4
    v_lshl_add_u32 v122, v114, 2, v118
    v_lshl_add_u32 v123, v114, 1, v119
    v_xor_b32 v123, 1, v123
    v_lshlrev_b32 v77, 7, v122
    v_lshl_add_u32 v77, v123, 4, v77
    s_waitcnt lgkmcnt(8)
    v_mfma_f32_32x32x16_bf16 v[16:31], v[64:67], v[68:71], v[16:31]
    ds_read_b128 v[64:67], v84 offset:288
    ds_read_b128 v[68:71], v85 offset:288
    v_lshl_add_u32 v77, v116, 1, v77
    v_add_u32 v77, 126976, v77
    v_cmp_eq_u32 vcc, 3, v118
    v_lshlrev_b32_e64 v78, 2, v118
    v_add_u32 v78, 127236, v78
    v_mov_b32 v122, 126976
    v_cndmask_b32 v78, v78, v122, vcc
    s_waitcnt lgkmcnt(8)
    v_mfma_f32_32x32x16_bf16 v[16:31], v[32:35], v[36:39], v[16:31]
    ds_read_b128 v[32:35], v84 offset:320
    ds_read_b128 v[36:39], v85 offset:320
    v_lshrrev_b32_e64 v79, 2, v2
    v_mul_u32_u24 v79, 40960, v79
    v_lshl_add_u32 v79, v118, 4, v79
    s_add_u32 s92, s100, 31981568
    s_addc_u32 s93, s101, 0
    s_mov_b32 s94, 24576
    s_waitcnt lgkmcnt(8)
    v_mfma_f32_32x32x16_bf16 v[16:31], v[40:43], v[44:47], v[16:31]
    ds_read_b128 v[40:43], v84 offset:352
    ds_read_b128 v[44:47], v85 offset:352
    s_mov_b32 s95, 0x00020000
    s_add_u32 s48, s100, 32505856
    s_addc_u32 s49, s101, 0
    s_mov_b32 s50, 221184
    s_mov_b32 s51, 0x00020000
    s_add_u32 s20, s100, 16777216
    s_waitcnt lgkmcnt(8)
    v_mfma_f32_32x32x16_bf16 v[16:31], v[48:51], v[52:55], v[16:31]
    ds_read_b128 v[48:51], v84 offset:384
    ds_read_b128 v[52:55], v85 offset:384
    s_addc_u32 s21, s101, 0
    s_mov_b32 s22, 2621440
    s_mov_b32 s23, 0x00020000
    s_mov_b32 s68, 0
    s_mov_b32 s69, 0x80000000
    s_cmp_eq_u32 s65, 3
    s_waitcnt lgkmcnt(8)
    v_mfma_f32_32x32x16_bf16 v[16:31], v[56:59], v[60:63], v[16:31]
    ds_read_b128 v[56:59], v84 offset:416
    ds_read_b128 v[60:63], v85 offset:416
    s_mov_b32 s70, 10813572
    s_cselect_b32 s70, 128255876, s70
    s_mov_b32 s71, 62718876
    s_cselect_b32 s71, 109840326, s71
    s_lshl_b32 s72, s64, 4
    s_lshr_b64 s[70:71], s[70:71], s72
    s_waitcnt lgkmcnt(8)
    v_mfma_f32_32x32x16_bf16 v[16:31], v[64:67], v[68:71], v[16:31]
    ds_read_b128 v[64:67], v84 offset:448
    ds_read_b128 v[68:71], v85 offset:448
    s_and_b32 s39, s70, 0xffff
    s_bfe_u32 s70, s39, 131072
    s_bfe_u32 s71, s39, 196610
    s_lshl_b32 s4, s70, 5
    s_lshl_b32 s5, s71, 12
    s_mul_i32 s6, s70, 4224
    s_add_u32 s6, s6, 114304
    s_waitcnt lgkmcnt(8)
    v_mfma_f32_32x32x16_bf16 v[16:31], v[32:35], v[36:39], v[16:31]
    ds_read_b128 v[32:35], v84 offset:480
    ds_read_b128 v[36:39], v85 offset:480
    s_lshr_b32 s24, s71, 1
    s_mul_i32 s25, s70, 5
    s_add_u32 s25, s25, s24
    s_lshl_b32 s25, s25, 4
    s_add_u32 s70, s70, s66
    s_lshl_b32 s70, s70, 6
    s_waitcnt lgkmcnt(8)
    v_mfma_f32_32x32x16_bf16 v[16:31], v[40:43], v[44:47], v[16:31]
    s_sub_u32 s71, s71, 1
    s_mul_i32 s26, s71, 327680
    s_add_u32 s26, s26, s70
    s_cmp_eq_u32 s24, 0
    s_cselect_b32 s27, 1, 0
    s_min_u32 s28, s24, 2
    s_waitcnt lgkmcnt(6)
    v_mfma_f32_32x32x16_bf16 v[16:31], v[48:51], v[52:55], v[16:31]
    s_bfe_u32 s70, s39, 131077
    s_bfe_u32 s71, s39, 196615
    s_lshl_b32 s29, s70, 5
    s_lshl_b32 s30, s71, 12
    s_mul_i32 s31, s70, 4224
    s_add_u32 s31, s31, 114304
    s_waitcnt lgkmcnt(4)
    v_mfma_f32_32x32x16_bf16 v[16:31], v[56:59], v[60:63], v[16:31]
    s_lshr_b32 s32, s71, 1
    s_mul_i32 s33, s70, 5
    s_add_u32 s33, s33, s32
    s_lshl_b32 s33, s33, 4
    s_add_u32 s70, s70, s66
    s_lshl_b32 s70, s70, 6
    s_waitcnt lgkmcnt(2)
    v_mfma_f32_32x32x16_bf16 v[16:31], v[64:67], v[68:71], v[16:31]
    s_sub_u32 s71, s71, 1
    s_mul_i32 s34, s71, 327680
    s_add_u32 s34, s34, s70
    s_cmp_eq_u32 s32, 0
    s_cselect_b32 s35, 1, 0
    s_min_u32 s36, s32, 2
    s_lshr_b32 s37, s39, 10
    s_waitcnt lgkmcnt(0)
    v_mfma_f32_32x32x16_bf16 v[16:31], v[32:35], v[36:39], v[16:31]
    s_nop 7
    s_nop 3
    s_mov_b64 exec, 1
    v_add_f32 v16, s3, v16
    s_mov_b64 exec, -1
    v_cvt_pk_bf16_f32 v32, v16, v17
    v_cvt_pk_bf16_f32 v33, v18, v19
    v_cvt_pk_bf16_f32 v34, v20, v20
    v_cvt_pk_bf16_f32 v35, v21, v22
    ds_write_b64 v86, v[32:33] offset:64
    v_cndmask_b32 v48, v24, v25, s[86:87]
    v_cndmask_b32 v49, v26, v27, s[86:87]
    ds_write_b64 v86, v[34:35] offset:576
    v_cvt_pk_bf16_f32 v36, v24, v24
    v_cvt_pk_bf16_f32 v37, v48, v25
    v_cvt_pk_bf16_f32 v38, v26, v26
    v_cvt_pk_bf16_f32 v39, v49, v27
    ds_write_b64 v86, v[36:37] offset:1088
    ds_write_b64 v86, v[38:39] offset:1600
    v_cvt_pk_bf16_f32 v40, v28, v28
    v_cvt_pk_bf16_f32 v41, v28, v28
    ds_write_b64 v86, v[40:41] offset:2112
    v_cvt_pk_bf16_f32 v42, v29, v29
    v_cvt_pk_bf16_f32 v43, v29, v29
    ds_write_b64 v86, v[42:43] offset:2624
    v_cvt_pk_bf16_f32 v44, v30, v30
    v_cvt_pk_bf16_f32 v45, v30, v30
    ds_write_b64 v86, v[44:45] offset:3136
    v_cvt_pk_bf16_f32 v46, v31, v31
    v_cvt_pk_bf16_f32 v47, v31, v31
    ds_write_b64 v86, v[46:47] offset:3648
    s_mov_b64 exec, 0x55555555
    ds_write_b16 v86, v40 offset:2120
    ds_write_b16 v86, v42 offset:2632
    ds_write_b16 v86, v44 offset:3144
    ds_write_b16 v86, v46 offset:3656
    s_mov_b32 exec_lo, 15
    s_mov_b32 exec_hi, 15
    ds_write_b64 v86, v[72:73]
    s_mov_b64 exec, -1
    s_branch L_kd76
L_kn77:
    v_and_b32 v112, 1, v2
    v_bfe_u32 v113, v2, 4, 1
    v_lshrrev_b32_e64 v114, 5, v2
    v_bfe_u32 v115, v2, 2, 2
    v_bfe_u32 v116, v2, 2, 3
    v_lshl_add_u32 v117, v114, 3, v115
    v_and_b32_e64 v118, 3, v2
    v_bfe_u32 v119, v2, 1, 1
    v_and_b32_e64 v121, 31, v2
    v_lshl_add_u32 v122, v114, 2, v121
    v_add_u32_e64 v122, 28, v122
    v_bfe_u32 v123, v122, 1, 3
    v_lshlrev_b32_e64 v3, 7, v122
    v_lshl_add_u32 v3, v123, 4, v3
    v_add_u32 v3, 119808, v3
    v_lshl_add_u32 v122, v113, 2, v118
    v_sub_u32 v122, v122, v117
    v_lshlrev_b32 v4, 3, v122
    v_add_u32 v4, 96, v4
    v_lshl_add_u32 v122, v114, 2, v118
    v_lshl_add_u32 v123, v114, 1, v119
    v_xor_b32 v123, 1, v123
    v_lshlrev_b32 v77, 7, v122
    v_lshl_add_u32 v77, v123, 4, v77
    v_lshl_add_u32 v77, v116, 1, v77
    v_add_u32 v77, 126976, v77
    v_cmp_eq_u32 vcc, 3, v118
    v_lshlrev_b32 v78, 2, v118
    v_add_u32 v78, 127236, v78
    v_mov_b32 v122, 126976
    v_cndmask_b32 v78, v78, v122, vcc
    v_lshrrev_b32 v79, 2, v2
    v_mul_u32_u24 v79, 40960, v79
    v_lshl_add_u32 v79, v118, 4, v79
    s_add_u32 s92, s100, 31981568
    s_addc_u32 s93, s101, 0
    s_mov_b32 s94, 24576
    s_mov_b32 s95, 0x00020000
    s_add_u32 s48, s100, 32505856
    s_addc_u32 s49, s101, 0
    s_mov_b32 s50, 221184
    s_mov_b32 s51, 0x00020000
    s_add_u32 s20, s100, 16777216
    s_addc_u32 s21, s101, 0
    s_mov_b32 s22, 2621440
    s_mov_b32 s23, 0x00020000
    s_mov_b32 s68, 0
    s_mov_b32 s69, 0x80000000
    s_cmp_eq_u32 s65, 3
    s_mov_b32 s70, 10813572
    s_cselect_b32 s70, 128255876, s70
    s_mov_b32 s71, 62718876
    s_cselect_b32 s71, 109840326, s71
    s_lshl_b32 s72, s64, 4
    s_lshr_b64 s[70:71], s[70:71], s72
    s_and_b32 s39, s70, 0xffff
    s_bfe_u32 s70, s39, 131072
    s_bfe_u32 s71, s39, 196610
    s_lshl_b32 s4, s70, 5
    s_lshl_b32 s5, s71, 12
    s_mul_i32 s6, s70, 4224
    s_add_u32 s6, s6, 114304
    s_lshr_b32 s24, s71, 1
    s_mul_i32 s25, s70, 5
    s_add_u32 s25, s25, s24
    s_lshl_b32 s25, s25, 4
    s_add_u32 s70, s70, s66
    s_lshl_b32 s70, s70, 6
    s_sub_u32 s71, s71, 1
    s_mul_i32 s26, s71, 327680
    s_add_u32 s26, s26, s70
    s_cmp_eq_u32 s24, 0
    s_cselect_b32 s27, 1, 0
    s_min_u32 s28, s24, 2
    s_bfe_u32 s70, s39, 131077
    s_bfe_u32 s71, s39, 196615
    s_lshl_b32 s29, s70, 5
    s_lshl_b32 s30, s71, 12
    s_mul_i32 s31, s70, 4224
    s_add_u32 s31, s31, 114304
    s_lshr_b32 s32, s71, 1
    s_mul_i32 s33, s70, 5
    s_add_u32 s33, s33, s32
    s_lshl_b32 s33, s33, 4
    s_add_u32 s70, s70, s66
    s_lshl_b32 s70, s70, 6
    s_sub_u32 s71, s71, 1
    s_mul_i32 s34, s71, 327680
    s_add_u32 s34, s34, s70
    s_cmp_eq_u32 s32, 0
    s_cselect_b32 s35, 1, 0
    s_min_u32 s36, s32, 2
    s_lshr_b32 s37, s39, 10
L_kd76:
    s_mul_i32 s98, s58, 2211840
    s_cmp_ge_u32 s2, 216
    s_waitcnt lgkmcnt(0)
    s_cbranch_scc1 L_nw278
    ds_read_b64_tr_b16 v[96:97], v83 offset:0
    ds_read_b64_tr_b16 v[98:99], v83 offset:2560
    ds_read_b64_tr_b16 v[100:101], v83 offset:128
    ds_read_b64_tr_b16 v[102:103], v83 offset:2688
    ds_read_b64_tr_b16 v[104:105], v83 offset:256
    ds_read_b64_tr_b16 v[106:107], v83 offset:2816
    s_and_b32 s86, s2, 3
    s_mul_i32 s86, s86, 552960
    s_lshr_b32 s87, s2, 2
    s_mul_i32 s87, s87, 5120
    s_add_u32 s86, s86, s87
    s_lshl_b32 s87, s76, 10
    s_add_u32 s86, s86, s87
    s_waitcnt lgkmcnt(4)
    buffer_store_dwordx4 v[96:99], v5, s[44:47], s86 offen sc1
    s_add_u32 s87, s86, 275456
    s_add_u32 s86, s86, 4096
    s_cmp_eq_u32 s76, 0
    s_cselect_b32 s86, s86, s87
    s_waitcnt lgkmcnt(2)
    buffer_store_dwordx4 v[100:103], v5, s[44:47], s86 offen sc1
    s_cmp_ge_u32 s64, 6
    s_cbranch_scc1 L_nw278
    s_add_u32 s87, s87, 4096
    s_waitcnt lgkmcnt(0)
    buffer_store_dwordx4 v[104:107], v5, s[44:47], s87 offen sc1
L_nw278:
    v_mov_b32 v13, v77
    v_mov_b32 v14, v78
    v_mov_b32 v15, v79
    v_xor_b32 v5, s4, v3
    v_add_u32 v7, s6, v4
    v_add_u32 v5, s5, v5
    v_xor_b32 v6, 64, v5
    v_xor_b32 v8, s4, v13
    v_add_u32 v10, s25, v14
    v_add_u32 v8, s5, v8
    v_xor_b32 v9, 64, v8
    s_xor_b32 s4, s4, 16
    s_add_u32 s5, s5, 126976
    s_add_u32 s67, s67, 110592
    s_lshl_b32 s84, s76, 10
    s_mul_i32 s38, s58, 110592
    s_mov_b32 m0, s84
    s_cmp_eq_u32 s28, 0
    s_cselect_b32 s40, -1, 0
    s_waitcnt lgkmcnt(0)
    s_barrier
    ds_read_b128 v[64:67], v5 offset:3072
    ds_read_b64_tr_b16 v[80:81], v7 offset:32
    ds_read_b64_tr_b16 v[82:83], v7 offset:0
    ds_read_b128 v[68:71], v6 offset:2048
    ds_read_b64_tr_b16 v[84:85], v7 offset:160
    ds_read_b64_tr_b16 v[86:87], v7 offset:128
    ds_read_b128 v[72:75], v5 offset:1024
    ds_read_b64_tr_b16 v[88:89], v7 offset:288
    ds_read_b64_tr_b16 v[90:91], v7 offset:256
    ds_read_b128 v[76:79], v6 offset:0
    ds_read_b64_tr_b16 v[92:93], v7 offset:416
    ds_read_b64_tr_b16 v[94:95], v7 offset:384
    ds_read_b128 v[48:51], v5 offset:7168
    ds_read_b128 v[52:55], v6 offset:6144
    ds_read_b128 v[56:59], v5 offset:5120
    ds_read_b128 v[60:63], v6 offset:4096
    s_lshl_b32 s85, s2, 3
    s_add_u32 s85, s85, s64
    s_cmp_lg_u32 s85, 4
    s_cbranch_scc1 L_nb79
    s_add_u32 s12, s100, 32768000
    s_addc_u32 s13, s101, 0
    s_mov_b32 s14, 64
    s_mov_b32 s15, 0x00020000
    v_mov_b32_e64 v16, s56
    v_mov_b32 v17, 0
    s_mov_b64 exec, 1
    buffer_store_dword v16, v17, s[12:15], 0 offen sc1
    s_mov_b64 exec, -1
L_nb79:
L_job80:
    s_waitcnt lgkmcnt(4)
    v_mfma_f32_32x32x16_bf16 v[32:47], v[64:67], v[80:83], 0
    v_subrev_u32 v5, 4096, v5
    v_subrev_u32 v6, 4096, v6
    v_add_u32 v7, 512, v7
    s_waitcnt lgkmcnt(3)
    v_mfma_f32_32x32x16_bf16 v[16:31], v[48:51], v[80:83], 0
    ds_read_b128 v[48:51], v5 offset:3072
    ds_read_b64_tr_b16 v[80:81], v7 offset:32
    ds_read_b64_tr_b16 v[82:83], v7 offset:0
    s_waitcnt lgkmcnt(5)
    v_mfma_f32_32x32x16_bf16 v[32:47], v[68:71], v[84:87], v[32:47]
    v_mfma_f32_32x32x16_bf16 v[16:31], v[52:55], v[84:87], v[16:31]
    ds_read_b128 v[52:55], v6 offset:2048
    ds_read_b64_tr_b16 v[84:85], v7 offset:160
    ds_read_b64_tr_b16 v[86:87], v7 offset:128
    s_waitcnt lgkmcnt(7)
    v_mfma_f32_32x32x16_bf16 v[32:47], v[72:75], v[88:91], v[32:47]
    v_mfma_f32_32x32x16_bf16 v[16:31], v[56:59], v[88:91], v[16:31]
    ds_read_b128 v[56:59], v5 offset:1024
    ds_read_b64_tr_b16 v[88:89], v7 offset:288
    ds_read_b64_tr_b16 v[90:91], v7 offset:256
    s_waitcnt lgkmcnt(9)
    v_mfma_f32_32x32x16_bf16 v[32:47], v[76:79], v[92:95], v[32:47]
    v_mfma_f32_32x32x16_bf16 v[16:31], v[60:63], v[92:95], v[16:31]
    ds_read_b128 v[60:63], v6 offset:0
    ds_read_b64_tr_b16 v[92:93], v7 offset:416
    ds_read_b64_tr_b16 v[94:95], v7 offset:384
    s_cmp_eq_u32 s24, 0
    s_cbranch_scc1 L_tail82
L_loop81:
    s_waitcnt lgkmcnt(9)
    v_mfma_f32_32x32x16_bf16 v[16:31], v[64:67], v[80:83], v[16:31]
    v_subrev_u32 v5, 4096, v5
    v_subrev_u32 v6, 4096, v6
    v_add_u32 v7, 512, v7
    ds_read_b128 v[64:67], v5 offset:3072
    v_mfma_f32_32x32x16_bf16 v[32:47], v[48:51], v[80:83], v[32:47]
    ds_read_b64_tr_b16 v[80:81], v7 offset:32
    ds_read_b64_tr_b16 v[82:83], v7 offset:0
    s_waitcnt lgkmcnt(9)
    v_mfma_f32_32x32x16_bf16 v[16:31], v[68:71], v[84:87], v[16:31]
    ds_read_b128 v[68:71], v6 offset:2048
    v_mfma_f32_32x32x16_bf16 v[32:47], v[52:55], v[84:87], v[32:47]
    ds_read_b64_tr_b16 v[84:85], v7 offset:160
    ds_read_b64_tr_b16 v[86:87], v7 offset:128
    s_waitcnt lgkmcnt(9)
    v_mfma_f32_32x32x16_bf16 v[16:31], v[72:75], v[88:91], v[16:31]
    ds_read_b128 v[72:75], v5 offset:1024
    v_mfma_f32_32x32x16_bf16 v[32:47], v[56:59], v[88:91], v[32:47]
    ds_read_b64_tr_b16 v[88:89], v7 offset:288
    ds_read_b64_tr_b16 v[90:91], v7 offset:256
    s_waitcnt lgkmcnt(9)
    v_mfma_f32_32x32x16_bf16 v[16:31], v[76:79], v[92:95], v[16:31]
    ds_read_b128 v[76:79], v6 offset:0
    v_mfma_f32_32x32x16_bf16 v[32:47], v[60:63], v[92:95], v[32:47]
    ds_read_b64_tr_b16 v[92:93], v7 offset:416
    ds_read_b64_tr_b16 v[94:95], v7 offset:384
    s_waitcnt lgkmcnt(9)
    v_mfma_f32_32x32x16_bf16 v[16:31], v[48:51], v[80:83], v[16:31]
    v_subrev_u32 v5, 4096, v5
    v_subrev_u32 v6, 4096, v6
    v_add_u32 v7, 512, v7
    ds_read_b128 v[48:51], v5 offset:3072
    v_mfma_f32_32x32x16_bf16 v[32:47], v[64:67], v[80:83], v[32:47]
    ds_read_b64_tr_b16 v[80:81], v7 offset:32
    ds_read_b64_tr_b16 v[82:83], v7 offset:0
    s_waitcnt lgkmcnt(9)
    v_mfma_f32_32x32x16_bf16 v[16:31], v[52:55], v[84:87], v[16:31]
    ds_read_b128 v[52:55], v6 offset:2048
    v_mfma_f32_32x32x16_bf16 v[32:47], v[68:71], v[84:87], v[32:47]
    ds_read_b64_tr_b16 v[84:85], v7 offset:160
    ds_read_b64_tr_b16 v[86:87], v7 offset:128
    s_waitcnt lgkmcnt(9)
    v_mfma_f32_32x32x16_bf16 v[16:31], v[56:59], v[88:91], v[16:31]
    ds_read_b128 v[56:59], v5 offset:1024
    v_mfma_f32_32x32x16_bf16 v[32:47], v[72:75], v[88:91], v[32:47]
    ds_read_b64_tr_b16 v[88:89], v7 offset:288
    ds_read_b64_tr_b16 v[90:91], v7 offset:256
    s_waitcnt lgkmcnt(9)
    v_mfma_f32_32x32x16_bf16 v[16:31], v[60:63], v[92:95], v[16:31]
    ds_read_b128 v[60:63], v6 offset:0
    v_mfma_f32_32x32x16_bf16 v[32:47], v[76:79], v[92:95], v[32:47]
    ds_read_b64_tr_b16 v[92:93], v7 offset:416
    ds_read_b64_tr_b16 v[94:95], v7 offset:384
    s_cmp_eq_u32 s40, -1
    s_cbranch_scc1 L_n286
    s_waitcnt vmcnt(0)
    s_lshl_b32 s85, s40, 2
    s_add_u32 s85, s85, 126980
    v_mov_b32_e64 v108, s85
    v_mov_b32 v109, 1
    s_mov_b64 exec, 1
    ds_add_rtn_u32 v109, v108, v109
    s_waitcnt lgkmcnt(0)
    v_readfirstlane_b32 s86, v109
    s_mov_b64 exec, -1
    s_lshr_b32 s85, s40, 1
    s_add_u32 s86, s86, 1
    s_lshl_b32 s85, s65, s85
    s_cmp_eq_u32 s40, 0
    s_cselect_b32 s85, 4, s85
    s_cmp_lg_u32 s86, s85
    s_cbranch_scc1 L_nf87
    v_lshlrev_b32_e64 v108, 10, v2
    v_mov_b32 v109, s56
    s_lshl_b32 s86, s2, 2
    s_lshl_b32 s85, s40, 13
    s_add_u32 s86, s86, s85
    s_mov_b64 exec, 0xff
    buffer_store_dword v109, v108, s[92:95], s86 offen sc1
    s_mov_b64 exec, -1
L_nf87:
    s_mov_b32 s40, -1
L_n286:
    s_sub_u32 s24, s24, 1
    s_cmp_lg_u32 s24, 0
    s_cbranch_scc1 L_loop81
L_tail82:
    s_waitcnt lgkmcnt(9)
    v_mfma_f32_32x32x16_bf16 v[16:31], v[64:67], v[80:83], v[16:31]
    v_xor_b32 v5, s29, v3
    v_add_u32 v7, s31, v4
    v_add_u32 v5, s30, v5
    v_xor_b32 v6, 64, v5
    ds_read_b128 v[64:67], v5 offset:3072
    ds_read_b64_tr_b16 v[80:81], v7 offset:32
    ds_read_b64_tr_b16 v[82:83], v7 offset:0
    ds_read_u16_d16_hi v48, v8 offset:0
    ds_read_u16_d16_hi v49, v9 offset:1024
    s_waitcnt lgkmcnt(11)
    v_mfma_f32_32x32x16_bf16 v[16:31], v[68:71], v[84:87], v[16:31]
    ds_read_b128 v[68:71], v6 offset:2048
    ds_read_b64_tr_b16 v[84:85], v7 offset:160
    ds_read_b64_tr_b16 v[86:87], v7 offset:128
    ds_read_u16_d16_hi v50, v8 offset:2048
    ds_read_u16_d16_hi v51, v9 offset:3072
    s_waitcnt lgkmcnt(13)
    v_mfma_f32_32x32x16_bf16 v[16:31], v[72:75], v[88:91], v[16:31]
    ds_read_b128 v[72:75], v5 offset:1024
    ds_read_b64_tr_b16 v[88:89], v7 offset:288
    ds_read_b64_tr_b16 v[90:91], v7 offset:256
    ds_read_u16_d16_hi v52, v8 offset:4096
    ds_read_u16_d16_hi v53, v9 offset:5120
    s_waitcnt lgkmcnt(15)
    v_mfma_f32_32x32x16_bf16 v[16:31], v[76:79], v[92:95], v[16:31]
    ds_read_b128 v[76:79], v6 offset:0
    ds_read_b64_tr_b16 v[92:93], v7 offset:416
    ds_read_b64_tr_b16 v[94:95], v7 offset:384
    ds_read_u16_d16_hi v54, v8 offset:6144
    ds_read_u16_d16_hi v55, v9 offset:7168
    ds_read_b32 v56, v10
    v_cndmask_b32 v57, v47, v43, s[68:69]
    v_cndmask_b32 v43, v43, v39, s[68:69]
    v_cndmask_b32 v39, v39, v35, s[68:69]
    v_add_f32_dpp v34, v35, v34 wave_shr:1 row_mask:0xf bank_mask:0xf bound_ctrl:0
    v_add_f32_dpp v46, v57, v46 wave_ror:1 row_mask:0xf bank_mask:0xf
    v_add_f32_dpp v42, v43, v42 wave_ror:1 row_mask:0xf bank_mask:0xf
    v_add_f32_dpp v38, v39, v38 wave_ror:1 row_mask:0xf bank_mask:0xf
    v_cndmask_b32 v57, v46, v42, s[68:69]
    v_cndmask_b32 v42, v42, v38, s[68:69]
    v_cndmask_b32 v38, v38, v34, s[68:69]
    v_add_f32_dpp v33, v34, v33 wave_shr:1 row_mask:0xf bank_mask:0xf bound_ctrl:0
    v_add_f32_dpp v45, v57, v45 wave_ror:1 row_mask:0xf bank_mask:0xf
    v_add_f32_dpp v41, v42, v41 wave_ror:1 row_mask:0xf bank_mask:0xf
    v_add_f32_dpp v37, v38, v37 wave_ror:1 row_mask:0xf bank_mask:0xf
    v_cndmask_b32 v57, v45, v41, s[68:69]
    v_cndmask_b32 v41, v41, v37, s[68:69]
    v_cndmask_b32 v37, v37, v33, s[68:69]
    v_add_f32_dpp v32, v33, v32 wave_shr:1 row_mask:0xf bank_mask:0xf bound_ctrl:0
    v_add_f32_dpp v44, v57, v44 wave_ror:1 row_mask:0xf bank_mask:0xf
    v_add_f32_dpp v40, v41, v40 wave_ror:1 row_mask:0xf bank_mask:0xf
    v_add_f32_dpp v36, v37, v36 wave_ror:1 row_mask:0xf bank_mask:0xf
    v_cndmask_b32 v57, v31, v27, s[68:69]
    v_cndmask_b32 v27, v27, v23, s[68:69]
    v_cndmask_b32 v23, v23, v19, s[68:69]
    v_cndmask_b32 v19, v19, v47, s[68:69]
    v_add_f32_dpp v30, v57, v30 wave_ror:1 row_mask:0xf bank_mask:0xf
    v_add_f32_dpp v26, v27, v26 wave_ror:1 row_mask:0xf bank_mask:0xf
    v_add_f32_dpp v22, v23, v22 wave_ror:1 row_mask:0xf bank_mask:0xf
    v_add_f32_dpp v18, v19, v18 wave_ror:1 row_mask:0xf bank_mask:0xf
    v_cndmask_b32 v57, v30, v26, s[68:69]
    v_cndmask_b32 v26, v26, v22, s[68:69]
    v_cndmask_b32 v22, v22, v18, s[68:69]
    v_cndmask_b32 v18, v18, v46, s[68:69]
    v_add_f32_dpp v29, v57, v29 wave_ror:1 row_mask:0xf bank_mask:0xf
    v_add_f32_dpp v25, v26, v25 wave_ror:1 row_mask:0xf bank_mask:0xf
    v_add_f32_dpp v21, v22, v21 wave_ror:1 row_mask:0xf bank_mask:0xf
    v_add_f32_dpp v17, v18, v17 wave_ror:1 row_mask:0xf bank_mask:0xf
    v_cndmask_b32 v57, v29, v25, s[68:69]
    v_cndmask_b32 v25, v25, v21, s[68:69]
    v_cndmask_b32 v21, v21, v17, s[68:69]
    v_cndmask_b32 v17, v17, v45, s[68:69]
    v_add_f32_dpp v28, v57, v28 wave_ror:1 row_mask:0xf bank_mask:0xf
    v_add_f32_dpp v24, v25, v24 wave_ror:1 row_mask:0xf bank_mask:0xf
    v_add_f32_dpp v20, v21, v20 wave_ror:1 row_mask:0xf bank_mask:0xf
    v_add_f32_dpp v16, v17, v16 wave_ror:1 row_mask:0xf bank_mask:0xf
    s_mov_b64 exec, s[68:69]
    ds_write_b128 v10, v[28:31] offset:272
    ds_write_b32 v10, v2 offset:16
    s_mov_b64 exec, -1
    v_bfe_u32 v38, v2, 1, 3
    v_lshl_add_u32 v39, v2, 7, s5
    v_lshlrev_b32 v38, 4, v38
    v_xor_b32_e64 v38, s4, v38
    v_add_u32 v38, v38, v39
    s_waitcnt lgkmcnt(2)
    v_readlane_b32 s86, v56, 3
    v_add_f32 v32, v32, v48
    v_add_f32 v36, v36, v49
    v_add_f32_e64 v40, v40, v50
    v_add_f32 v44, v44, v51
    s_or_b32 s86, s86, s27
    s_cbranch_scc1 L_ok83
    s_mov_b32 s87, 0
L_sp84:
    ds_read_b32 v56, v10
    s_add_u32 s87, s87, 1
    s_waitcnt lgkmcnt(0)
    v_readlane_b32 s86, v56, 3
    s_cmp_lg_u32 s86, 0
    s_cbranch_scc1 L_ok83
    s_sleep 1
    s_cmp_lt_u32 s87, 200000
    s_cbranch_scc1 L_sp84
L_ok83:
    v_add_f32 v16, v16, v52
    v_add_f32 v20, v20, v53
    v_add_f32_e64 v24, v24, v54
    v_add_f32 v28, v28, v55
    s_mov_b64 exec, 7
    v_add_f32 v32, v32, v56
    s_mov_b64 exec, -1
    v_cvt_pk_bf16_f32 v33, v32, v36
    ds_read_b128 v[48:51], v5 offset:7168
    v_cvt_pk_bf16_f32 v34, v40, v44
    ds_read_b128 v[52:55], v6 offset:6144
    v_cvt_pk_bf16_f32 v35, v16, v20
    ds_read_b128 v[56:59], v5 offset:5120
    v_cvt_pk_bf16_f32 v37, v24, v28
    ds_read_b128 v[60:63], v6 offset:4096
    ds_write_b16 v8, v33 offset:0
    ds_write_b16_d16_hi v9, v33 offset:1024
    ds_write_b16 v8, v34 offset:2048
    ds_write_b16_d16_hi v9, v34 offset:3072
    ds_write_b16 v8, v35 offset:4096
    ds_write_b16_d16_hi v9, v35 offset:5120
    ds_write_b16 v8, v37 offset:6144
    ds_write_b16_d16_hi v9, v37 offset:7168
    ds_read_b128 v[40:43], v38
    s_waitcnt lgkmcnt(0)
    buffer_store_dwordx4 v[40:43], v15, s[20:23], s26 offen sc1
    s_cmp_lg_u32 s37, 1
    s_cbranch_scc1 L_fin85
    s_mov_b32 s37, 2
    s_mov_b32 s40, s28
    s_mov_b32 s24, s32
    s_mov_b32 s26, s34
    s_mov_b32 s27, s35
    s_mov_b32 s28, s36
    v_xor_b32 v8, s29, v13
    v_add_u32 v10, s33, v14
    v_add_u32 v8, s30, v8
    v_xor_b32 v9, 64, v8
    s_xor_b32 s4, s29, 16
    s_add_u32 s5, s30, 126976
    s_branch L_job80
L_fin85:
    s_waitcnt lgkmcnt(0)
    s_mov_b32 s30, s64
    s_mov_b32 s32, s57
    s_and_b32 s31, s2, 1
    s_lshl_b32 s31, s31, 2
    s_bfe_u32 s33, s2, 0x20003
    s_add_u32 s31, s31, s33
    s_add_u32 s24, s100, 19922944
    s_addc_u32 s25, s101, 0
    s_mov_b32 s26, 32768
    s_mov_b32 s27, 0x00020000
    s_add_u32 s40, s100, 20971520
    s_addc_u32 s41, s101, 0
    s_mov_b32 s42, 7077888
    s_mov_b32 s43, 0x00020000
    s_and_b32 s8, s2, 7
    s_lshl_b32 s8, s8, 10
    s_add_u32 s9, s8, 8192
    s_add_u32 s10, s8, 16384
    s_and_b32 s66, s2, 7
    s_bfe_u32 s67, s2, 0x30003
    s_lshr_b32 s59, s2, 6
    s_lshl_b32 s72, s66, 4
    s_add_u32 s72, s72, s59
    s_mul_i32 s72, s72, 55296
    s_add_u32 s73, s72, 221184
    s_add_u32 s74, s72, 442368
    s_add_u32 s75, s72, 663552
    s_lshr_b32 s76, s59, 1
    s_mul_i32 s76, s76, 40960
    s_and_b32 s77, s59, 1
    s_mul_i32 s77, s77, 2560
    s_add_u32 s76, s76, s77
    s_mul_i32 s77, s67, 160
    s_add_u32 s76, s76, s77
    s_mul_i32 s77, s66, 81920
    s_add_u32 s76, s76, s77
    s_add_u32 s78, s76, s77
    s_add_u32 s77, s76, 655360
    s_add_u32 s79, s78, 1392640
    s_add_u32 s78, s78, 1310720
    s_lshl_b32 s4, s66, 3
    s_lshr_b32 s5, s59, 1
    s_add_u32 s4, s4, s5
    s_mul_i32 s4, s4, 3456
    s_add_u32 s5, s4, 6912
    s_add_u32 s6, s4, 13824
    s_add_u32 s7, s4, 20736
    s_and_b32 s29, s30, 3
    v_lshlrev_b32 v10, 4, v2
    v_add_u32 v11, 4096, v10
    s_mul_i32 s34, s29, 5120
    s_mul_i32 s33, s31, 81920
    s_add_u32 s11, s33, s33
    s_add_u32 s33, s33, s34
    s_add_u32 s11, s11, s34
    s_lshl_b32 s12, s29, 8
    s_lshl_b32 s13, s31, 10
    s_add_u32 s14, s13, s13
    s_add_u32 s13, s13, s12
    s_add_u32 s14, s14, s12
    s_add_u32 s12, s12, 81920
    v_add_u32_e64 v8, s12, v10
    s_mul_i32 s39, s67, 276480
    s_mul_i32 s36, s29, 46080
    s_add_u32 s36, s36, s39
    s_mul_i32 s37, s29, 19456
    v_min_u32 v12, 26, v2
    v_lshlrev_b32 v12, 7, v12
    s_cmp_eq_u32 s30, 7
    s_cselect_b32 s35, 0, 0x7ff00000
    v_add_u32 v12, s35, v12
    v_add_u32 v9, s35, v10
    v_lshrrev_b32 v13, 1, v2
    v_lshlrev_b32 v13, 6, v13
    v_and_b32_e64 v14, 1, v2
    v_lshl_add_u32 v13, v14, 4, v13
    s_mul_i32 s35, s30, 5120
    v_add_u32_e64 v14, s35, v10
    v_add_u32 v15, 86016, v14
    v_add_u32 v14, 40960, v14
    s_mul_i32 s83, s29, 9216
    s_mov_b32 s15, 0
    s_waitcnt vmcnt(0)
    s_lshl_b32 s85, s28, 2
    s_add_u32 s85, s85, 126980
    v_mov_b32 v58, s85
    v_mov_b32 v59, 1
    s_mov_b64 exec, 1
    ds_add_rtn_u32 v59, v58, v59
    s_waitcnt lgkmcnt(0)
    v_readfirstlane_b32 s86, v59
    s_mov_b64 exec, -1
    s_lshr_b32 s85, s28, 1
    s_add_u32 s86, s86, 1
    s_lshl_b32 s85, s65, s85
    s_cmp_eq_u32 s28, 0
    s_cselect_b32 s85, 4, s85
    s_cmp_lg_u32 s86, s85
    s_cbranch_scc1 L_nf89
    v_lshlrev_b32_e64 v58, 10, v2
    v_mov_b32 v59, s56
    s_lshl_b32 s86, s2, 2
    s_lshl_b32 s85, s28, 13
    s_add_u32 s86, s86, s85
    s_mov_b64 exec, 0xff
    buffer_store_dword v59, v58, s[92:95], s86 offen sc1
    s_mov_b64 exec, -1
L_nf89:
L_dc88:
    s_cmp_eq_u32 s58, 0
    s_cbranch_scc1 L_nw90
    v_mov_b32 v58, 127000
    s_mov_b32 s87, 0
L_sp91:
    ds_read_b32 v59, v58
    s_add_u32 s87, s87, 1
    s_waitcnt lgkmcnt(0)
    v_readfirstlane_b32 s86, v59
    s_cmp_ge_u32 s86, 4
    s_cbranch_scc1 L_sd92
    s_sleep 1
    s_cmp_lt_u32 s87, 200000
    s_cbranch_scc1 L_sp91
L_sd92:
L_nw90:
    s_cmp_eq_u32 s58, 0
    s_cbranch_scc1 L_idleh3
    s_add_u32 m0, s34, 40960
    s_add_u32 s35, s33, 40960
    buffer_load_dwordx4 v10, s[20:23], s35 offen offset:0 sc1 lds
    buffer_load_dwordx4 v10, s[20:23], s35 offen offset:1024 sc1 lds
    buffer_load_dwordx4 v10, s[20:23], s35 offen offset:2048 sc1 lds
    buffer_load_dwordx4 v10, s[20:23], s35 offen offset:3072 sc1 lds
    s_add_u32 m0, s34, 45056
    s_nop 0
    buffer_load_dwordx4 v11, s[20:23], s35 offen sc1 lds
    s_add_u32 s35, s36, 0
    buffer_load_dwordx4 v[76:79], v10, s[44:47], s35 offen offset:0 sc1
    buffer_load_dwordx4 v[80:83], v10, s[44:47], s35 offen offset:1024 sc1
    buffer_load_dwordx4 v[84:87], v10, s[44:47], s35 offen offset:2048 sc1
    buffer_load_dwordx4 v[88:91], v10, s[44:47], s35 offen offset:3072 sc1
    s_add_u32 s35, s36, 4096
    buffer_load_dwordx4 v[92:95], v10, s[44:47], s35 offen offset:0 sc1
    buffer_load_dwordx4 v[96:99], v10, s[44:47], s35 offen offset:1024 sc1
    buffer_load_dwordx4 v[100:103], v10, s[44:47], s35 offen offset:2048 sc1
    buffer_load_dwordx4 v[104:107], v10, s[44:47], s35 offen offset:3072 sc1
    s_waitcnt lgkmcnt(0)
    s_barrier
    buffer_load_dwordx4 v[4:7], v9, s[92:95], s9 offen sc1
    s_add_u32 s35, s36, 8192
    buffer_load_dwordx4 v[108:111], v10, s[44:47], s35 offen offset:0 sc1
    buffer_load_dwordx4 v[112:115], v10, s[44:47], s35 offen offset:1024 sc1
    buffer_load_dwordx4 v[116:119], v10, s[44:47], s35 offen offset:2048 sc1
    buffer_load_dwordx4 v[120:123], v10, s[44:47], s35 offen offset:3072 sc1
    s_add_u32 s35, s36, 12288
    buffer_load_dwordx4 v[124:127], v10, s[44:47], s35 offen offset:0 sc1
    buffer_load_dwordx4 v[128:131], v10, s[44:47], s35 offen offset:1024 sc1
    buffer_load_dwordx4 v[132:135], v10, s[44:47], s35 offen offset:2048 sc1
    buffer_load_dwordx4 v[136:139], v10, s[44:47], s35 offen offset:3072 sc1
    s_add_u32 s35, s36, 16384
    buffer_load_dwordx4 v[140:143], v10, s[44:47], s35 offen offset:0 sc1
    buffer_load_dwordx4 v[144:147], v10, s[44:47], s35 offen offset:1024 sc1
    buffer_load_dwordx4 v[148:151], v10, s[44:47], s35 offen offset:2048 sc1
    buffer_load_dwordx4 v[152:155], v10, s[44:47], s35 offen offset:3072 sc1
    s_barrier
    s_add_u32 m0, s34, 61440
    s_add_u32 s35, s33, 61440
    buffer_load_dwordx4 v10, s[20:23], s35 offen offset:0 sc1 lds
    buffer_load_dwordx4 v10, s[20:23], s35 offen offset:1024 sc1 lds
    buffer_load_dwordx4 v10, s[20:23], s35 offen offset:2048 sc1 lds
    buffer_load_dwordx4 v10, s[20:23], s35 offen offset:3072 sc1 lds
    s_add_u32 m0, s34, 65536
    s_nop 0
    buffer_load_dwordx4 v11, s[20:23], s35 offen sc1 lds
    s_add_u32 m0, s12, 0
    s_add_u32 s35, s13, 0
    s_mov_b64 exec, 0xffff
    buffer_load_dwordx4 v10, s[24:27], s35 offen sc1 lds
    s_mov_b64 exec, -1
    s_add_u32 s35, s36, 20480
    buffer_load_dwordx4 v[156:159], v10, s[44:47], s35 offen offset:0 sc1
    buffer_load_dwordx4 v[160:163], v10, s[44:47], s35 offen offset:1024 sc1
    buffer_load_dwordx4 v[164:167], v10, s[44:47], s35 offen offset:2048 sc1
    buffer_load_dwordx4 v[168:171], v10, s[44:47], s35 offen offset:3072 sc1
    s_waitcnt vmcnt(31)
    s_waitcnt vmcnt(22)
    s_cmp_lg_u32 s30, 7
    s_cbranch_scc1 L_o793
    s_mov_b32 s87, 0
L_pl94:
    v_xor_b32 v4, s56, v4
    v_xor_b32 v5, s56, v5
    v_xor_b32 v6, s56, v6
    v_xor_b32_e64 v7, s56, v7
    v_or3_b32 v4, v4, v5, v6
    v_or_b32_e64 v4, v4, v7
    v_cmp_ne_u32 vcc, 0, v4
    s_add_u32 s87, s87, 1
    s_cbranch_vccz L_pd95
    s_sleep 4
    buffer_load_dwordx4 v[4:7], v10, s[92:95], s9 offen sc1
    s_cmp_lt_u32 s87, 20000
    s_waitcnt vmcnt(0)
    s_cbranch_scc1 L_pl94
L_pd95:
L_o793:
    s_barrier
    s_add_u32 m0, s34, 0
    s_add_u32 s35, s33, 655360
    buffer_load_dwordx4 v10, s[20:23], s35 offen offset:0 sc1 lds
    buffer_load_dwordx4 v10, s[20:23], s35 offen offset:1024 sc1 lds
    buffer_load_dwordx4 v10, s[20:23], s35 offen offset:2048 sc1 lds
    buffer_load_dwordx4 v10, s[20:23], s35 offen offset:3072 sc1 lds
    s_add_u32 m0, s34, 4096
    s_nop 0
    buffer_load_dwordx4 v11, s[20:23], s35 offen sc1 lds
    s_add_u32 s35, s36, 24576
    buffer_load_dwordx4 v[172:175], v10, s[44:47], s35 offen offset:0 sc1
    buffer_load_dwordx4 v[176:179], v10, s[44:47], s35 offen offset:1024 sc1
    buffer_load_dwordx4 v[180:183], v10, s[44:47], s35 offen offset:2048 sc1
    buffer_load_dwordx4 v[184:187], v10, s[44:47], s35 offen offset:3072 sc1
    s_waitcnt vmcnt(14)
    s_waitcnt vmcnt(13)
    s_mov_b32 s87, 0
L_sl96:
    s_mov_b64 exec, 0xffff
    ds_read_b32 v3, v8 offset:12
    s_add_u32 s87, s87, 1
    s_waitcnt lgkmcnt(0)
    v_cmp_ne_u32 vcc, s56, v3
    s_mov_b64 exec, -1
    s_cbranch_vccz L_sd97
    s_sleep 2
    s_add_u32 m0, s12, 0
    s_add_u32 s35, s13, 0
    s_mov_b64 exec, 0xffff
    buffer_load_dwordx4 v10, s[24:27], s35 offen sc1 lds
    s_mov_b64 exec, -1
    s_cmp_lt_u32 s87, 20000
    s_waitcnt vmcnt(0)
    s_cbranch_scc1 L_sl96
L_sd97:
    s_barrier
    s_add_u32 m0, s34, 20480
    s_add_u32 s35, s33, 675840
    buffer_load_dwordx4 v10, s[20:23], s35 offen offset:0 sc1 lds
    buffer_load_dwordx4 v10, s[20:23], s35 offen offset:1024 sc1 lds
    buffer_load_dwordx4 v10, s[20:23], s35 offen offset:2048 sc1 lds
    buffer_load_dwordx4 v10, s[20:23], s35 offen offset:3072 sc1 lds
    s_add_u32 m0, s34, 24576
    s_nop 0
    buffer_load_dwordx4 v11, s[20:23], s35 offen sc1 lds
    s_add_u32 s35, s36, 28672
    buffer_load_dwordx4 v[188:191], v10, s[44:47], s35 offen offset:0 sc1
    buffer_load_dwordx4 v[192:195], v10, s[44:47], s35 offen offset:1024 sc1
    buffer_load_dwordx4 v[196:199], v10, s[44:47], s35 offen offset:2048 sc1
    buffer_load_dwordx4 v[200:203], v10, s[44:47], s35 offen offset:3072 sc1
    s_waitcnt vmcnt(13)
    s_barrier
    buffer_load_dwordx4 v[4:7], v9, s[92:95], s10 offen sc1
    s_add_u32 m0, s34, 40960
    s_add_u32 s35, s33, 696320
    buffer_load_dwordx4 v10, s[20:23], s35 offen offset:0 sc1 lds
    buffer_load_dwordx4 v10, s[20:23], s35 offen offset:1024 sc1 lds
    buffer_load_dwordx4 v10, s[20:23], s35 offen offset:2048 sc1 lds
    buffer_load_dwordx4 v10, s[20:23], s35 offen offset:3072 sc1 lds
    s_add_u32 m0, s34, 45056
    s_nop 0
    buffer_load_dwordx4 v11, s[20:23], s35 offen sc1 lds
    s_add_u32 s35, s36, 32768
    buffer_load_dwordx4 v[204:207], v10, s[44:47], s35 offen offset:0 sc1
    buffer_load_dwordx4 v[208:211], v10, s[44:47], s35 offen offset:1024 sc1
    buffer_load_dwordx4 v[212:215], v10, s[44:47], s35 offen offset:2048 sc1
    buffer_load_dwordx4 v[216:219], v10, s[44:47], s35 offen offset:3072 sc1
    s_waitcnt vmcnt(14)
    s_barrier
    s_add_u32 m0, s34, 61440
    s_add_u32 s35, s33, 716800
    buffer_load_dwordx4 v10, s[20:23], s35 offen offset:0 sc1 lds
    buffer_load_dwordx4 v10, s[20:23], s35 offen offset:1024 sc1 lds
    buffer_load_dwordx4 v10, s[20:23], s35 offen offset:2048 sc1 lds
    buffer_load_dwordx4 v10, s[20:23], s35 offen offset:3072 sc1 lds
    s_add_u32 m0, s34, 65536
    s_nop 0
    buffer_load_dwordx4 v11, s[20:23], s35 offen sc1 lds
    s_add_u32 m0, s12, 1024
    s_add_u32 s35, s13, 8192
    s_mov_b64 exec, 0xffff
    buffer_load_dwordx4 v10, s[24:27], s35 offen sc1 lds
    s_mov_b64 exec, -1
    s_add_u32 s35, s36, 36864
    buffer_load_dwordx4 v[220:223], v10, s[44:47], s35 offen offset:0 sc1
    buffer_load_dwordx4 v[224:227], v10, s[44:47], s35 offen offset:1024 sc1
    buffer_load_dwordx4 v[228:231], v10, s[44:47], s35 offen offset:2048 sc1
    buffer_load_dwordx4 v[232:235], v10, s[44:47], s35 offen offset:3072 sc1
    s_waitcnt vmcnt(14)
    s_cmp_lg_u32 s30, 7
    s_cbranch_scc1 L_o798
    s_mov_b32 s87, 0
L_pl99:
    v_xor_b32 v4, s56, v4
    v_xor_b32 v5, s56, v5
    v_xor_b32 v6, s56, v6
    v_xor_b32 v7, s56, v7
    v_or3_b32 v4, v4, v5, v6
    v_or_b32_e64 v4, v4, v7
    v_cmp_ne_u32 vcc, 0, v4
    s_add_u32 s87, s87, 1
    s_cbranch_vccz L_pd100
    s_sleep 4
    buffer_load_dwordx4 v[4:7], v10, s[92:95], s10 offen sc1
    s_cmp_lt_u32 s87, 20000
    s_waitcnt vmcnt(0)
    s_cbranch_scc1 L_pl99
L_pd100:
L_o798:
    s_barrier
    s_add_u32 m0, s34, 0
    s_add_u32 s35, s11, 1310720
    buffer_load_dwordx4 v10, s[20:23], s35 offen offset:0 sc1 lds
    buffer_load_dwordx4 v10, s[20:23], s35 offen offset:1024 sc1 lds
    buffer_load_dwordx4 v10, s[20:23], s35 offen offset:2048 sc1 lds
    buffer_load_dwordx4 v10, s[20:23], s35 offen offset:3072 sc1 lds
    s_add_u32 m0, s34, 4096
    s_nop 0
    buffer_load_dwordx4 v11, s[20:23], s35 offen sc1 lds
    s_add_u32 s35, s36, 40960
    buffer_load_dwordx4 v[236:239], v10, s[44:47], s35 offen offset:0 sc1
    buffer_load_dwordx4 v[240:243], v10, s[44:47], s35 offen offset:1024 sc1
    buffer_load_dwordx4 v[244:247], v10, s[44:47], s35 offen offset:2048 sc1
    buffer_load_dwordx4 v[248:251], v10, s[44:47], s35 offen offset:3072 sc1
    s_waitcnt vmcnt(14)
    s_waitcnt vmcnt(13)
    s_mov_b32 s87, 0
L_sl101:
    s_mov_b64 exec, 0xffff
    ds_read_b32 v3, v8 offset:1036
    s_add_u32 s87, s87, 1
    s_waitcnt lgkmcnt(0)
    v_cmp_ne_u32 vcc, s56, v3
    s_mov_b64 exec, -1
    s_cbranch_vccz L_sd102
    s_sleep 2
    s_add_u32 m0, s12, 1024
    s_add_u32 s35, s13, 8192
    s_mov_b64 exec, 0xffff
    buffer_load_dwordx4 v10, s[24:27], s35 offen sc1 lds
    s_mov_b64 exec, -1
    s_cmp_lt_u32 s87, 20000
    s_waitcnt vmcnt(0)
    s_cbranch_scc1 L_sl101
L_sd102:
    s_barrier
    s_add_u32 m0, s34, 20480
    s_add_u32 s35, s11, 1331200
    buffer_load_dwordx4 v10, s[20:23], s35 offen offset:0 sc1 lds
    buffer_load_dwordx4 v10, s[20:23], s35 offen offset:1024 sc1 lds
    buffer_load_dwordx4 v10, s[20:23], s35 offen offset:2048 sc1 lds
    buffer_load_dwordx4 v10, s[20:23], s35 offen offset:3072 sc1 lds
    s_add_u32 m0, s34, 24576
    s_nop 0
    buffer_load_dwordx4 v11, s[20:23], s35 offen sc1 lds
    s_add_u32 s35, s36, 45056
    buffer_load_dwordx4 v[252:255], v10, s[44:47], s35 offen offset:0 sc1
    s_waitcnt vmcnt(10)
    s_barrier
    s_add_u32 m0, s34, 40960
    s_add_u32 s35, s11, 1351680
    buffer_load_dwordx4 v10, s[20:23], s35 offen offset:0 sc1 lds
    buffer_load_dwordx4 v10, s[20:23], s35 offen offset:1024 sc1 lds
    buffer_load_dwordx4 v10, s[20:23], s35 offen offset:2048 sc1 lds
    buffer_load_dwordx4 v10, s[20:23], s35 offen offset:3072 sc1 lds
    s_add_u32 m0, s34, 45056
    s_nop 0
    buffer_load_dwordx4 v11, s[20:23], s35 offen sc1 lds
    s_add_u32 m0, s37, 86016
    s_add_u32 s35, s37, s39
    s_add_u32 s35, s35, 184320
    buffer_load_dwordx4 v10, s[44:47], s35 offen offset:0 sc1 lds
    buffer_load_dwordx4 v10, s[44:47], s35 offen offset:1024 sc1 lds
    buffer_load_dwordx4 v10, s[44:47], s35 offen offset:2048 sc1 lds
    buffer_load_dwordx4 v10, s[44:47], s35 offen offset:3072 sc1 lds
    s_waitcnt vmcnt(10)
    s_barrier
    s_add_u32 m0, s34, 61440
    s_add_u32 s35, s11, 1372160
    buffer_load_dwordx4 v10, s[20:23], s35 offen offset:0 sc1 lds
    buffer_load_dwordx4 v10, s[20:23], s35 offen offset:1024 sc1 lds
    buffer_load_dwordx4 v10, s[20:23], s35 offen offset:2048 sc1 lds
    buffer_load_dwordx4 v10, s[20:23], s35 offen offset:3072 sc1 lds
    s_add_u32 m0, s34, 65536
    s_nop 0
    buffer_load_dwordx4 v11, s[20:23], s35 offen sc1 lds
    s_add_u32 m0, s12, 2048
    s_add_u32 s35, s14, 16384
    s_mov_b64 exec, 0xffff
    buffer_load_dwordx4 v10, s[24:27], s35 offen sc1 lds
    s_mov_b64 exec, -1
    s_add_u32 m0, s37, 90112
    s_add_u32 s35, s37, s39
    s_add_u32 s35, s35, 188416
    buffer_load_dwordx4 v10, s[44:47], s35 offen offset:0 sc1 lds
    buffer_load_dwordx4 v10, s[44:47], s35 offen offset:1024 sc1 lds
    buffer_load_dwordx4 v10, s[44:47], s35 offen offset:2048 sc1 lds
    buffer_load_dwordx4 v10, s[44:47], s35 offen offset:3072 sc1 lds
    s_waitcnt vmcnt(14)
    s_barrier
    s_add_u32 m0, s34, 0
    s_add_u32 s35, s11, 1392640
    buffer_load_dwordx4 v10, s[20:23], s35 offen offset:0 sc1 lds
    buffer_load_dwordx4 v10, s[20:23], s35 offen offset:1024 sc1 lds
    buffer_load_dwordx4 v10, s[20:23], s35 offen offset:2048 sc1 lds
    buffer_load_dwordx4 v10, s[20:23], s35 offen offset:3072 sc1 lds
    s_add_u32 m0, s34, 4096
    s_nop 0
    buffer_load_dwordx4 v11, s[20:23], s35 offen sc1 lds
    s_add_u32 m0, s37, 94208
    s_add_u32 s35, s37, s39
    s_add_u32 s35, s35, 192512
    buffer_load_dwordx4 v10, s[44:47], s35 offen offset:0 sc1 lds
    buffer_load_dwordx4 v10, s[44:47], s35 offen offset:1024 sc1 lds
    buffer_load_dwordx4 v10, s[44:47], s35 offen offset:2048 sc1 lds
    buffer_load_dwordx4 v10, s[44:47], s35 offen offset:3072 sc1 lds
    s_waitcnt vmcnt(14)
    s_waitcnt vmcnt(13)
    s_mov_b32 s87, 0
L_sl103:
    s_mov_b64 exec, 0xffff
    ds_read_b32 v3, v8 offset:2060
    s_add_u32 s87, s87, 1
    s_waitcnt lgkmcnt(0)
    v_cmp_ne_u32 vcc, s56, v3
    s_mov_b64 exec, -1
    s_cbranch_vccz L_sd104
    s_sleep 2
    s_add_u32 m0, s12, 2048
    s_add_u32 s35, s14, 16384
    s_mov_b64 exec, 0xffff
    buffer_load_dwordx4 v10, s[24:27], s35 offen sc1 lds
    s_mov_b64 exec, -1
    s_cmp_lt_u32 s87, 20000
    s_waitcnt vmcnt(0)
    s_cbranch_scc1 L_sl103
L_sd104:
    s_barrier
    s_add_u32 m0, s34, 20480
    s_add_u32 s35, s11, 1413120
    buffer_load_dwordx4 v10, s[20:23], s35 offen offset:0 sc1 lds
    buffer_load_dwordx4 v10, s[20:23], s35 offen offset:1024 sc1 lds
    buffer_load_dwordx4 v10, s[20:23], s35 offen offset:2048 sc1 lds
    buffer_load_dwordx4 v10, s[20:23], s35 offen offset:3072 sc1 lds
    s_add_u32 m0, s34, 24576
    s_nop 0
    buffer_load_dwordx4 v11, s[20:23], s35 offen sc1 lds
    s_add_u32 m0, s37, 98304
    s_add_u32 s35, s37, s39
    s_add_u32 s35, s35, 196608
    buffer_load_dwordx4 v10, s[44:47], s35 offen offset:0 sc1 lds
    buffer_load_dwordx4 v10, s[44:47], s35 offen offset:1024 sc1 lds
    buffer_load_dwordx4 v10, s[44:47], s35 offen offset:2048 sc1 lds
    buffer_load_dwordx4 v10, s[44:47], s35 offen offset:3072 sc1 lds
    s_waitcnt vmcnt(13)
    s_barrier
    s_add_u32 m0, s34, 40960
    s_add_u32 s35, s11, 1433600
    buffer_load_dwordx4 v10, s[20:23], s35 offen offset:0 sc1 lds
    buffer_load_dwordx4 v10, s[20:23], s35 offen offset:1024 sc1 lds
    buffer_load_dwordx4 v10, s[20:23], s35 offen offset:2048 sc1 lds
    buffer_load_dwordx4 v10, s[20:23], s35 offen offset:3072 sc1 lds
    s_add_u32 m0, s34, 45056
    s_nop 0
    buffer_load_dwordx4 v11, s[20:23], s35 offen sc1 lds
    s_add_u32 m0, s37, 102400
    s_add_u32 s35, s37, s39
    s_add_u32 s35, s35, 200704
    buffer_load_dwordx4 v10, s[44:47], s35 offen offset:0 sc1 lds
    buffer_load_dwordx4 v10, s[44:47], s35 offen offset:1024 sc1 lds
    buffer_load_dwordx4 v10, s[44:47], s35 offen offset:2048 sc1 lds
    s_waitcnt vmcnt(12)
    s_barrier
    s_add_u32 m0, s34, 61440
    s_add_u32 s35, s11, 1454080
    buffer_load_dwordx4 v10, s[20:23], s35 offen offset:0 sc1 lds
    buffer_load_dwordx4 v10, s[20:23], s35 offen offset:1024 sc1 lds
    buffer_load_dwordx4 v10, s[20:23], s35 offen offset:2048 sc1 lds
    buffer_load_dwordx4 v10, s[20:23], s35 offen offset:3072 sc1 lds
    s_add_u32 m0, s34, 65536
    s_nop 0
    buffer_load_dwordx4 v11, s[20:23], s35 offen sc1 lds
    s_add_u32 m0, s12, 3072
    s_add_u32 s35, s14, 17408
    s_mov_b64 exec, 0xffff
    buffer_load_dwordx4 v10, s[24:27], s35 offen sc1 lds
    s_mov_b64 exec, -1
    s_lshl_b32 s35, s29, 12
    s_add_u32 m0, s35, 0
    s_add_u32 s35, s35, s39
    s_add_u32 s35, s35, 261120
    buffer_load_dwordx4 v10, s[44:47], s35 offen offset:0 sc1 lds
    buffer_load_dwordx4 v10, s[44:47], s35 offen offset:1024 sc1 lds
    buffer_load_dwordx4 v10, s[44:47], s35 offen offset:2048 sc1 lds
    buffer_load_dwordx4 v10, s[44:47], s35 offen offset:3072 sc1 lds
    buffer_load_dwordx4 v[20:23], v12, s[48:51], s4 offen sc1
    buffer_load_dwordx4 v[24:27], v12, s[48:51], s5 offen sc1
    s_waitcnt vmcnt(15)
    s_barrier
    s_cmp_lg_u32 s30, 7
    s_cbranch_scc1 L_o7105
    v_mov_b32 v3, 16384
    v_mov_b32 v16, 0
    v_mov_b32 v17, 0
    v_mov_b32 v18, 0
    v_mov_b32_e64 v19, 0
    ds_write_b128 v3, v[16:19]
    s_waitcnt lgkmcnt(0)
L_o7105:
    s_mov_b32 s35, s76
    s_cmp_eq_u32 s29, 1
    s_cselect_b32 s35, s77, s35
    s_cmp_eq_u32 s29, 2
    s_cselect_b32 s35, s78, s35
    s_cmp_eq_u32 s29, 3
    s_cselect_b32 s35, s79, s35
    s_mul_i32 s38, s67, 4960
    s_add_u32 s35, s35, s38
    s_and_b32 s38, s59, 1
    s_mul_i32 s38, s38, 2528
    s_sub_u32 s35, s35, s38
    s_mul_i32 s38, s29, 3072
    s_add_u32 m0, s38, 20480
    s_nop 0
    buffer_load_dwordx4 v13, s[20:23], s35 offen sc1 lds
    s_add_u32 s35, s35, 2048
    s_add_u32 m0, s38, 21504
    s_nop 0
    buffer_load_dwordx4 v13, s[20:23], s35 offen sc1 lds
    s_add_u32 s35, s35, 2048
    s_add_u32 m0, s38, 22528
    s_nop 0
    buffer_load_dwordx4 v13, s[20:23], s35 offen sc1 lds
    s_waitcnt vmcnt(10)
    s_waitcnt vmcnt(9)
    s_mov_b32 s87, 0
L_sl106:
    s_mov_b64 exec, 0xffff
    ds_read_b32 v3, v8 offset:3084
    s_add_u32 s87, s87, 1
    s_waitcnt lgkmcnt(0)
    v_cmp_ne_u32 vcc, s56, v3
    s_mov_b64 exec, -1
    s_cbranch_vccz L_sd107
    s_sleep 2
    s_add_u32 m0, s12, 3072
    s_add_u32 s35, s14, 17408
    s_mov_b64 exec, 0xffff
    buffer_load_dwordx4 v10, s[24:27], s35 offen sc1 lds
    s_mov_b64 exec, -1
    s_cmp_lt_u32 s87, 20000
    s_waitcnt vmcnt(0)
    s_cbranch_scc1 L_sl106
L_sd107:
    s_waitcnt vmcnt(3)
    s_cmp_lg_u32 s30, 7
    s_cbranch_scc1 L_o7108
    s_mov_b32 s87, 0
L_pl109:
    v_xor_b32 v20, s56, v20
    v_xor_b32 v21, s56, v21
    v_xor_b32 v22, s56, v22
    v_xor_b32 v23, s56, v23
    v_or3_b32 v20, v20, v21, v22
    v_or_b32_e64 v20, v20, v23
    v_cmp_ne_u32 vcc, 0, v20
    s_add_u32 s87, s87, 1
    s_cbranch_vccz L_pd110
    s_sleep 8
    buffer_load_dwordx4 v[20:23], v12, s[48:51], s4 offen sc1
    s_cmp_lt_u32 s87, 20000
    s_waitcnt vmcnt(0)
    s_cbranch_scc1 L_pl109
L_pd110:
    s_mov_b32 s87, 0
L_pl111:
    v_xor_b32 v24, s56, v24
    v_xor_b32 v25, s56, v25
    v_xor_b32 v26, s56, v26
    v_xor_b32_e64 v27, s56, v27
    v_or3_b32 v24, v24, v25, v26
    v_or_b32_e64 v24, v24, v27
    v_cmp_ne_u32 vcc, 0, v24
    s_add_u32 s87, s87, 1
    s_cbranch_vccz L_pd112
    s_sleep 8
    buffer_load_dwordx4 v[24:27], v12, s[48:51], s5 offen sc1
    s_cmp_lt_u32 s87, 20000
    s_waitcnt vmcnt(0)
    s_cbranch_scc1 L_pl111
L_pd112:
L_o7108:
    s_barrier
    s_add_u32 s80, s72, s83
    s_add_u32 s81, s80, 4096
    s_add_u32 s82, s80, 8192
    buffer_load_dwordx4 v[40:43], v10, s[40:43], s80 offen offset:0 sc1
    buffer_load_dwordx4 v[44:47], v10, s[40:43], s80 offen offset:1024 sc1
    buffer_load_dwordx4 v[48:51], v10, s[40:43], s80 offen offset:2048 sc1
    buffer_load_dwordx4 v[52:55], v10, s[40:43], s80 offen offset:3072 sc1
    buffer_load_dwordx4 v[56:59], v10, s[40:43], s81 offen offset:0 sc1
    buffer_load_dwordx4 v[60:63], v10, s[40:43], s81 offen offset:1024 sc1
    buffer_load_dwordx4 v[64:67], v10, s[40:43], s81 offen offset:2048 sc1
    buffer_load_dwordx4 v[68:71], v10, s[40:43], s81 offen offset:3072 sc1
    buffer_load_dwordx4 v[72:75], v10, s[40:43], s82 offen offset:0 sc1
    s_barrier
L_g2h5:
    s_waitcnt vmcnt(8)
    v_mfma_f32_16x16x32_bf16 v[20:23], v[76:79], v[40:43], 0
    s_add_u32 s80, s73, s83
    s_add_u32 s81, s80, 4096
    s_add_u32 s82, s80, 8192
    v_mfma_f32_16x16x32_bf16 v[24:27], v[80:83], v[40:43], 0
    v_mfma_f32_16x16x32_bf16 v[28:31], v[84:87], v[40:43], 0
    v_mfma_f32_16x16x32_bf16 v[32:35], v[88:91], v[40:43], 0
    v_mfma_f32_16x16x32_bf16 v[36:39], v[92:95], v[40:43], 0
    buffer_load_dwordx4 v[40:43], v10, s[40:43], s80 offen offset:0 sc1
    s_waitcnt vmcnt(8)
    v_mfma_f32_16x16x32_bf16 v[20:23], v[96:99], v[44:47], v[20:23]
    v_mfma_f32_16x16x32_bf16 v[24:27], v[100:103], v[44:47], v[24:27]
    v_mfma_f32_16x16x32_bf16 v[28:31], v[104:107], v[44:47], v[28:31]
    v_mfma_f32_16x16x32_bf16 v[32:35], v[108:111], v[44:47], v[32:35]
    v_mfma_f32_16x16x32_bf16 v[36:39], v[112:115], v[44:47], v[36:39]
    buffer_load_dwordx4 v[44:47], v10, s[40:43], s80 offen offset:1024 sc1
    s_waitcnt vmcnt(8)
    v_mfma_f32_16x16x32_bf16 v[20:23], v[116:119], v[48:51], v[20:23]
    v_mfma_f32_16x16x32_bf16 v[24:27], v[120:123], v[48:51], v[24:27]
    v_mfma_f32_16x16x32_bf16 v[28:31], v[124:127], v[48:51], v[28:31]
    v_mfma_f32_16x16x32_bf16 v[32:35], v[128:131], v[48:51], v[32:35]
    v_mfma_f32_16x16x32_bf16 v[36:39], v[132:135], v[48:51], v[36:39]
    buffer_load_dwordx4 v[48:51], v10, s[40:43], s80 offen offset:2048 sc1
    s_waitcnt vmcnt(8)
    v_mfma_f32_16x16x32_bf16 v[20:23], v[136:139], v[52:55], v[20:23]
    v_mfma_f32_16x16x32_bf16 v[24:27], v[140:143], v[52:55], v[24:27]
    v_mfma_f32_16x16x32_bf16 v[28:31], v[144:147], v[52:55], v[28:31]
    v_mfma_f32_16x16x32_bf16 v[32:35], v[148:151], v[52:55], v[32:35]
    v_mfma_f32_16x16x32_bf16 v[36:39], v[152:155], v[52:55], v[36:39]
    buffer_load_dwordx4 v[52:55], v10, s[40:43], s80 offen offset:3072 sc1
    s_waitcnt vmcnt(8)
    v_mfma_f32_16x16x32_bf16 v[20:23], v[156:159], v[56:59], v[20:23]
    buffer_load_dwordx4 v[16:19], v12, s[48:51], s6 offen sc1
    v_mfma_f32_16x16x32_bf16 v[24:27], v[160:163], v[56:59], v[24:27]
    v_mfma_f32_16x16x32_bf16 v[28:31], v[164:167], v[56:59], v[28:31]
    v_mfma_f32_16x16x32_bf16 v[32:35], v[168:171], v[56:59], v[32:35]
    v_mfma_f32_16x16x32_bf16 v[36:39], v[172:175], v[56:59], v[36:39]
    buffer_load_dwordx4 v[56:59], v10, s[40:43], s81 offen offset:0 sc1
    s_waitcnt vmcnt(9)
    v_mfma_f32_16x16x32_bf16 v[20:23], v[176:179], v[60:63], v[20:23]
    v_mfma_f32_16x16x32_bf16 v[24:27], v[180:183], v[60:63], v[24:27]
    v_mfma_f32_16x16x32_bf16 v[28:31], v[184:187], v[60:63], v[28:31]
    v_mfma_f32_16x16x32_bf16 v[32:35], v[188:191], v[60:63], v[32:35]
    v_mfma_f32_16x16x32_bf16 v[36:39], v[192:195], v[60:63], v[36:39]
    buffer_load_dwordx4 v[60:63], v10, s[40:43], s81 offen offset:1024 sc1
    s_waitcnt vmcnt(9)
    v_mfma_f32_16x16x32_bf16 v[20:23], v[196:199], v[64:67], v[20:23]
    v_mfma_f32_16x16x32_bf16 v[24:27], v[200:203], v[64:67], v[24:27]
    v_mfma_f32_16x16x32_bf16 v[28:31], v[204:207], v[64:67], v[28:31]
    v_mfma_f32_16x16x32_bf16 v[32:35], v[208:211], v[64:67], v[32:35]
    v_mfma_f32_16x16x32_bf16 v[36:39], v[212:215], v[64:67], v[36:39]
    buffer_load_dwordx4 v[64:67], v10, s[40:43], s81 offen offset:2048 sc1
    s_waitcnt vmcnt(9)
    v_mfma_f32_16x16x32_bf16 v[20:23], v[216:219], v[68:71], v[20:23]
    v_mfma_f32_16x16x32_bf16 v[24:27], v[220:223], v[68:71], v[24:27]
    v_mfma_f32_16x16x32_bf16 v[28:31], v[224:227], v[68:71], v[28:31]
    v_mfma_f32_16x16x32_bf16 v[32:35], v[228:231], v[68:71], v[32:35]
    v_mfma_f32_16x16x32_bf16 v[36:39], v[232:235], v[68:71], v[36:39]
    buffer_load_dwordx4 v[68:71], v10, s[40:43], s81 offen offset:3072 sc1
    s_waitcnt vmcnt(9)
    v_mfma_f32_16x16x32_bf16 v[20:23], v[236:239], v[72:75], v[20:23]
    v_mfma_f32_16x16x32_bf16 v[24:27], v[240:243], v[72:75], v[24:27]
    v_mfma_f32_16x16x32_bf16 v[28:31], v[244:247], v[72:75], v[28:31]
    v_mfma_f32_16x16x32_bf16 v[32:35], v[248:251], v[72:75], v[32:35]
    ds_write_b128 v14, v[20:23] offset:0
    v_mfma_f32_16x16x32_bf16 v[36:39], v[252:255], v[72:75], v[36:39]
    ds_write_b128 v14, v[24:27] offset:1024
    buffer_load_dwordx4 v[72:75], v10, s[40:43], s82 offen offset:0 sc1
    s_waitcnt vmcnt(9)
    v_mfma_f32_16x16x32_bf16 v[20:23], v[76:79], v[40:43], 0
    ds_write_b128 v14, v[28:31] offset:2048
    s_add_u32 s80, s74, s83
    s_add_u32 s81, s80, 4096
    s_add_u32 s82, s80, 8192
    v_mfma_f32_16x16x32_bf16 v[24:27], v[80:83], v[40:43], 0
    ds_write_b128 v14, v[32:35] offset:3072
    v_mfma_f32_16x16x32_bf16 v[28:31], v[84:87], v[40:43], 0
    ds_write_b128 v14, v[36:39] offset:4096
    v_mfma_f32_16x16x32_bf16 v[32:35], v[88:91], v[40:43], 0
    v_mfma_f32_16x16x32_bf16 v[36:39], v[92:95], v[40:43], 0
    s_waitcnt vmcnt(8)
    v_mfma_f32_16x16x32_bf16 v[20:23], v[96:99], v[44:47], v[20:23]
    v_mfma_f32_16x16x32_bf16 v[24:27], v[100:103], v[44:47], v[24:27]
    v_mfma_f32_16x16x32_bf16 v[28:31], v[104:107], v[44:47], v[28:31]
    v_mfma_f32_16x16x32_bf16 v[32:35], v[108:111], v[44:47], v[32:35]
    v_mfma_f32_16x16x32_bf16 v[36:39], v[112:115], v[44:47], v[36:39]
    s_waitcnt vmcnt(5)
    s_cmp_lg_u32 s64, 7
    s_cbranch_scc1 L_ow113
    s_mov_b32 s87, 0
L_pl115:
    v_xor_b32 v16, s56, v16
    v_xor_b32 v17, s56, v17
    v_xor_b32 v18, s56, v18
    v_xor_b32 v19, s56, v19
    v_or3_b32 v16, v16, v17, v18
    v_or_b32_e64 v16, v16, v19
    v_cmp_ne_u32 vcc, 0, v16
    s_add_u32 s87, s87, 1
    s_cbranch_vccz L_pd116
    s_sleep 8
    buffer_load_dwordx4 v[16:19], v12, s[48:51], s6 offen sc1
    s_cmp_lt_u32 s87, 20000
    s_waitcnt vmcnt(0)
    s_cbranch_scc1 L_pl115
L_pd116:
    v_mov_b32 v16, 16392
    v_mov_b32 v17, 1
    s_mov_b64 exec, 1
    ds_add_u32 v16, v17
    s_mov_b64 exec, -1
    s_branch L_dn114
L_ow113:
    v_mov_b32 v16, 16392
    s_mov_b32 s87, 0
L_sp117:
    ds_read_b32 v17, v16
    s_add_u32 s87, s87, 1
    s_waitcnt lgkmcnt(0)
    v_readfirstlane_b32 s86, v17
    s_cmp_ge_u32 s86, 1
    s_cbranch_scc1 L_sd118
    s_sleep 1
    s_cmp_lt_u32 s87, 200000
    s_cbranch_scc1 L_sp117
L_sd118:
L_dn114:
    buffer_load_dwordx4 v[40:43], v10, s[40:43], s80 offen offset:0 sc1
    buffer_load_dwordx4 v[44:47], v10, s[40:43], s80 offen offset:1024 sc1
    v_mfma_f32_16x16x32_bf16 v[20:23], v[116:119], v[48:51], v[20:23]
    v_mfma_f32_16x16x32_bf16 v[24:27], v[120:123], v[48:51], v[24:27]
    v_mfma_f32_16x16x32_bf16 v[28:31], v[124:127], v[48:51], v[28:31]
    v_mfma_f32_16x16x32_bf16 v[32:35], v[128:131], v[48:51], v[32:35]
    v_mfma_f32_16x16x32_bf16 v[36:39], v[132:135], v[48:51], v[36:39]
    buffer_load_dwordx4 v[48:51], v10, s[40:43], s80 offen offset:2048 sc1
    v_mfma_f32_16x16x32_bf16 v[20:23], v[136:139], v[52:55], v[20:23]
    v_mfma_f32_16x16x32_bf16 v[24:27], v[140:143], v[52:55], v[24:27]
    v_mfma_f32_16x16x32_bf16 v[28:31], v[144:147], v[52:55], v[28:31]
    v_mfma_f32_16x16x32_bf16 v[32:35], v[148:151], v[52:55], v[32:35]
    v_mfma_f32_16x16x32_bf16 v[36:39], v[152:155], v[52:55], v[36:39]
    buffer_load_dwordx4 v[52:55], v10, s[40:43], s80 offen offset:3072 sc1
    s_waitcnt vmcnt(8)
    v_mfma_f32_16x16x32_bf16 v[20:23], v[156:159], v[56:59], v[20:23]
    v_mfma_f32_16x16x32_bf16 v[24:27], v[160:163], v[56:59], v[24:27]
    s_waitcnt lgkmcnt(0)
    s_barrier
    v_mfma_f32_16x16x32_bf16 v[28:31], v[164:167], v[56:59], v[28:31]
    v_mfma_f32_16x16x32_bf16 v[32:35], v[168:171], v[56:59], v[32:35]
    v_mfma_f32_16x16x32_bf16 v[36:39], v[172:175], v[56:59], v[36:39]
    buffer_load_dwordx4 v[56:59], v10, s[40:43], s81 offen offset:0 sc1
    s_waitcnt vmcnt(8)
    v_mfma_f32_16x16x32_bf16 v[20:23], v[176:179], v[60:63], v[20:23]
    v_mfma_f32_16x16x32_bf16 v[24:27], v[180:183], v[60:63], v[24:27]
    v_mfma_f32_16x16x32_bf16 v[28:31], v[184:187], v[60:63], v[28:31]
    v_mfma_f32_16x16x32_bf16 v[32:35], v[188:191], v[60:63], v[32:35]
    v_mfma_f32_16x16x32_bf16 v[36:39], v[192:195], v[60:63], v[36:39]
    buffer_load_dwordx4 v[60:63], v10, s[40:43], s81 offen offset:1024 sc1
    s_waitcnt vmcnt(8)
    v_mfma_f32_16x16x32_bf16 v[20:23], v[196:199], v[64:67], v[20:23]
    v_mfma_f32_16x16x32_bf16 v[24:27], v[200:203], v[64:67], v[24:27]
    v_mfma_f32_16x16x32_bf16 v[28:31], v[204:207], v[64:67], v[28:31]
    v_mfma_f32_16x16x32_bf16 v[32:35], v[208:211], v[64:67], v[32:35]
    v_mfma_f32_16x16x32_bf16 v[36:39], v[212:215], v[64:67], v[36:39]
    buffer_load_dwordx4 v[64:67], v10, s[40:43], s81 offen offset:2048 sc1
    s_waitcnt vmcnt(8)
    v_mfma_f32_16x16x32_bf16 v[20:23], v[216:219], v[68:71], v[20:23]
    buffer_load_dwordx4 v[16:19], v12, s[48:51], s7 offen sc1
    v_mfma_f32_16x16x32_bf16 v[24:27], v[220:223], v[68:71], v[24:27]
    v_mfma_f32_16x16x32_bf16 v[28:31], v[224:227], v[68:71], v[28:31]
    v_mfma_f32_16x16x32_bf16 v[32:35], v[228:231], v[68:71], v[32:35]
    v_mfma_f32_16x16x32_bf16 v[36:39], v[232:235], v[68:71], v[36:39]
    buffer_load_dwordx4 v[68:71], v10, s[40:43], s81 offen offset:3072 sc1
    s_waitcnt vmcnt(9)
    v_mfma_f32_16x16x32_bf16 v[20:23], v[236:239], v[72:75], v[20:23]
    v_mfma_f32_16x16x32_bf16 v[24:27], v[240:243], v[72:75], v[24:27]
    v_mfma_f32_16x16x32_bf16 v[28:31], v[244:247], v[72:75], v[28:31]
    v_mfma_f32_16x16x32_bf16 v[32:35], v[248:251], v[72:75], v[32:35]
    ds_write_b128 v15, v[20:23] offset:0
    v_mfma_f32_16x16x32_bf16 v[36:39], v[252:255], v[72:75], v[36:39]
    ds_write_b128 v15, v[24:27] offset:1024
    buffer_load_dwordx4 v[72:75], v10, s[40:43], s82 offen offset:0 sc1
    s_waitcnt vmcnt(9)
    v_mfma_f32_16x16x32_bf16 v[20:23], v[76:79], v[40:43], 0
    ds_write_b128 v15, v[28:31] offset:2048
    s_add_u32 s80, s75, s83
    s_add_u32 s81, s80, 4096
    s_add_u32 s82, s80, 8192
    v_mfma_f32_16x16x32_bf16 v[24:27], v[80:83], v[40:43], 0
    ds_write_b128 v15, v[32:35] offset:3072
    v_mfma_f32_16x16x32_bf16 v[28:31], v[84:87], v[40:43], 0
    ds_write_b128 v15, v[36:39] offset:4096
    v_mfma_f32_16x16x32_bf16 v[32:35], v[88:91], v[40:43], 0
    v_mfma_f32_16x16x32_bf16 v[36:39], v[92:95], v[40:43], 0
    s_waitcnt vmcnt(8)
    v_mfma_f32_16x16x32_bf16 v[20:23], v[96:99], v[44:47], v[20:23]
    v_mfma_f32_16x16x32_bf16 v[24:27], v[100:103], v[44:47], v[24:27]
    v_mfma_f32_16x16x32_bf16 v[28:31], v[104:107], v[44:47], v[28:31]
    v_mfma_f32_16x16x32_bf16 v[32:35], v[108:111], v[44:47], v[32:35]
    v_mfma_f32_16x16x32_bf16 v[36:39], v[112:115], v[44:47], v[36:39]
    s_waitcnt vmcnt(7)
    v_mfma_f32_16x16x32_bf16 v[20:23], v[116:119], v[48:51], v[20:23]
    v_mfma_f32_16x16x32_bf16 v[24:27], v[120:123], v[48:51], v[24:27]
    s_waitcnt lgkmcnt(0)
    s_barrier
    v_mfma_f32_16x16x32_bf16 v[28:31], v[124:127], v[48:51], v[28:31]
    v_mfma_f32_16x16x32_bf16 v[32:35], v[128:131], v[48:51], v[32:35]
    v_mfma_f32_16x16x32_bf16 v[36:39], v[132:135], v[48:51], v[36:39]
    s_waitcnt vmcnt(6)
    v_mfma_f32_16x16x32_bf16 v[20:23], v[136:139], v[52:55], v[20:23]
    v_mfma_f32_16x16x32_bf16 v[24:27], v[140:143], v[52:55], v[24:27]
    v_mfma_f32_16x16x32_bf16 v[28:31], v[144:147], v[52:55], v[28:31]
    v_mfma_f32_16x16x32_bf16 v[32:35], v[148:151], v[52:55], v[32:35]
    v_mfma_f32_16x16x32_bf16 v[36:39], v[152:155], v[52:55], v[36:39]
    s_waitcnt vmcnt(5)
    v_mfma_f32_16x16x32_bf16 v[20:23], v[156:159], v[56:59], v[20:23]
    v_mfma_f32_16x16x32_bf16 v[24:27], v[160:163], v[56:59], v[24:27]
    v_mfma_f32_16x16x32_bf16 v[28:31], v[164:167], v[56:59], v[28:31]
    v_mfma_f32_16x16x32_bf16 v[32:35], v[168:171], v[56:59], v[32:35]
    v_mfma_f32_16x16x32_bf16 v[36:39], v[172:175], v[56:59], v[36:39]
    s_waitcnt vmcnt(2)
    s_cmp_lg_u32 s64, 7
    s_cbranch_scc1 L_ow119
    s_mov_b32 s87, 0
L_pl121:
    v_xor_b32 v16, s56, v16
    v_xor_b32 v17, s56, v17
    v_xor_b32 v18, s56, v18
    v_xor_b32_e64 v19, s56, v19
    v_or3_b32 v16, v16, v17, v18
    v_or_b32_e64 v16, v16, v19
    v_cmp_ne_u32 vcc, 0, v16
    s_add_u32 s87, s87, 1
    s_cbranch_vccz L_pd122
    s_sleep 8
    buffer_load_dwordx4 v[16:19], v12, s[48:51], s7 offen sc1
    s_cmp_lt_u32 s87, 20000
    s_waitcnt vmcnt(0)
    s_cbranch_scc1 L_pl121
L_pd122:
    v_mov_b32 v16, 16396
    v_mov_b32 v17, 1
    s_mov_b64 exec, 1
    ds_add_u32 v16, v17
    s_mov_b64 exec, -1
    s_branch L_dn120
L_ow119:
    v_mov_b32 v16, 16396
    s_mov_b32 s87, 0
L_sp123:
    ds_read_b32 v17, v16
    s_add_u32 s87, s87, 1
    s_waitcnt lgkmcnt(0)
    v_readfirstlane_b32 s86, v17
    s_cmp_ge_u32 s86, 1
    s_cbranch_scc1 L_sd124
    s_sleep 1
    s_cmp_lt_u32 s87, 200000
    s_cbranch_scc1 L_sp123
L_sd124:
L_dn120:
    buffer_load_dwordx4 v[40:43], v10, s[40:43], s80 offen offset:0 sc1
    buffer_load_dwordx4 v[44:47], v10, s[40:43], s80 offen offset:1024 sc1
    buffer_load_dwordx4 v[48:51], v10, s[40:43], s80 offen offset:2048 sc1
    buffer_load_dwordx4 v[52:55], v10, s[40:43], s80 offen offset:3072 sc1
    buffer_load_dwordx4 v[56:59], v10, s[40:43], s81 offen offset:0 sc1
    v_mfma_f32_16x16x32_bf16 v[20:23], v[176:179], v[60:63], v[20:23]
    v_mfma_f32_16x16x32_bf16 v[24:27], v[180:183], v[60:63], v[24:27]
    v_mfma_f32_16x16x32_bf16 v[28:31], v[184:187], v[60:63], v[28:31]
    v_mfma_f32_16x16x32_bf16 v[32:35], v[188:191], v[60:63], v[32:35]
    v_mfma_f32_16x16x32_bf16 v[36:39], v[192:195], v[60:63], v[36:39]
    buffer_load_dwordx4 v[60:63], v10, s[40:43], s81 offen offset:1024 sc1
    v_mfma_f32_16x16x32_bf16 v[20:23], v[196:199], v[64:67], v[20:23]
    v_mfma_f32_16x16x32_bf16 v[24:27], v[200:203], v[64:67], v[24:27]
    v_mfma_f32_16x16x32_bf16 v[28:31], v[204:207], v[64:67], v[28:31]
    v_mfma_f32_16x16x32_bf16 v[32:35], v[208:211], v[64:67], v[32:35]
    v_mfma_f32_16x16x32_bf16 v[36:39], v[212:215], v[64:67], v[36:39]
    buffer_load_dwordx4 v[64:67], v10, s[40:43], s81 offen offset:2048 sc1
    s_waitcnt vmcnt(8)
    v_mfma_f32_16x16x32_bf16 v[20:23], v[216:219], v[68:71], v[20:23]
    v_mfma_f32_16x16x32_bf16 v[24:27], v[220:223], v[68:71], v[24:27]
    v_mfma_f32_16x16x32_bf16 v[28:31], v[224:227], v[68:71], v[28:31]
    v_mfma_f32_16x16x32_bf16 v[32:35], v[228:231], v[68:71], v[32:35]
    v_mfma_f32_16x16x32_bf16 v[36:39], v[232:235], v[68:71], v[36:39]
    buffer_load_dwordx4 v[68:71], v10, s[40:43], s81 offen offset:3072 sc1
    s_waitcnt vmcnt(8)
    v_mfma_f32_16x16x32_bf16 v[20:23], v[236:239], v[72:75], v[20:23]
    v_mfma_f32_16x16x32_bf16 v[24:27], v[240:243], v[72:75], v[24:27]
    v_mfma_f32_16x16x32_bf16 v[28:31], v[244:247], v[72:75], v[28:31]
    v_mfma_f32_16x16x32_bf16 v[32:35], v[248:251], v[72:75], v[32:35]
    ds_write_b128 v14, v[20:23] offset:0
    v_mfma_f32_16x16x32_bf16 v[36:39], v[252:255], v[72:75], v[36:39]
    ds_write_b128 v14, v[24:27] offset:1024
    buffer_load_dwordx4 v[72:75], v10, s[40:43], s82 offen offset:0 sc1
    s_waitcnt vmcnt(8)
    v_mfma_f32_16x16x32_bf16 v[20:23], v[76:79], v[40:43], 0
    ds_write_b128 v14, v[28:31] offset:2048
    v_mfma_f32_16x16x32_bf16 v[24:27], v[80:83], v[40:43], 0
    ds_write_b128 v14, v[32:35] offset:3072
    v_mfma_f32_16x16x32_bf16 v[28:31], v[84:87], v[40:43], 0
    ds_write_b128 v14, v[36:39] offset:4096
    v_mfma_f32_16x16x32_bf16 v[32:35], v[88:91], v[40:43], 0
    v_mfma_f32_16x16x32_bf16 v[36:39], v[92:95], v[40:43], 0
    s_waitcnt vmcnt(7)
    v_mfma_f32_16x16x32_bf16 v[20:23], v[96:99], v[44:47], v[20:23]
    s_lshl_b32 s35, s29, 8
    s_add_u32 s35, s35, 90112
    v_lshl_add_u32 v5, v2, 2, s35
    v_mfma_f32_16x16x32_bf16 v[24:27], v[100:103], v[44:47], v[24:27]
    v_mfma_f32_16x16x32_bf16 v[28:31], v[104:107], v[44:47], v[28:31]
    v_mfma_f32_16x16x32_bf16 v[32:35], v[108:111], v[44:47], v[32:35]
    v_mfma_f32_16x16x32_bf16 v[36:39], v[112:115], v[44:47], v[36:39]
    s_waitcnt vmcnt(6)
    v_mfma_f32_16x16x32_bf16 v[20:23], v[116:119], v[48:51], v[20:23]
    s_lshl_b32 s35, s29, 7
    s_add_u32 s35, s35, 22528
    v_and_b32 v3, 3, v2
    v_mfma_f32_16x16x32_bf16 v[24:27], v[120:123], v[48:51], v[24:27]
    s_waitcnt lgkmcnt(0)
    s_barrier
    v_mfma_f32_16x16x32_bf16 v[28:31], v[124:127], v[48:51], v[28:31]
    v_mfma_f32_16x16x32_bf16 v[32:35], v[128:131], v[48:51], v[32:35]
    v_mfma_f32_16x16x32_bf16 v[36:39], v[132:135], v[48:51], v[36:39]
    s_waitcnt vmcnt(5)
    v_mfma_f32_16x16x32_bf16 v[20:23], v[136:139], v[52:55], v[20:23]
    v_lshl_add_u32 v6, v3, 5, s35
    v_lshrrev_b32 v7, 2, v2
    v_lshl_add_u32 v6, v7, 1, v6
    v_mfma_f32_16x16x32_bf16 v[24:27], v[140:143], v[52:55], v[24:27]
    v_mfma_f32_16x16x32_bf16 v[28:31], v[144:147], v[52:55], v[28:31]
    v_mfma_f32_16x16x32_bf16 v[32:35], v[148:151], v[52:55], v[32:35]
    v_mfma_f32_16x16x32_bf16 v[36:39], v[152:155], v[52:55], v[36:39]
    s_waitcnt vmcnt(4)
    v_mfma_f32_16x16x32_bf16 v[20:23], v[156:159], v[56:59], v[20:23]
    v_and_b32 v7, 28, v2
    v_lshrrev_b32 v3, 5, v2
    v_add_u32 v7, v7, v3
    v_mfma_f32_16x16x32_bf16 v[24:27], v[160:163], v[56:59], v[24:27]
    v_mfma_f32_16x16x32_bf16 v[28:31], v[164:167], v[56:59], v[28:31]
    v_mfma_f32_16x16x32_bf16 v[32:35], v[168:171], v[56:59], v[32:35]
    v_mfma_f32_16x16x32_bf16 v[36:39], v[172:175], v[56:59], v[36:39]
    s_waitcnt vmcnt(3)
    v_mfma_f32_16x16x32_bf16 v[20:23], v[176:179], v[60:63], v[20:23]
    v_mul_u32_u24 v7, 1280, v7
    s_lshl_b32 s35, s29, 3
    s_add_u32 s35, s35, 128
    v_mfma_f32_16x16x32_bf16 v[24:27], v[180:183], v[60:63], v[24:27]
    v_mfma_f32_16x16x32_bf16 v[28:31], v[184:187], v[60:63], v[28:31]
    v_mfma_f32_16x16x32_bf16 v[32:35], v[188:191], v[60:63], v[32:35]
    v_mfma_f32_16x16x32_bf16 v[36:39], v[192:195], v[60:63], v[36:39]
    s_waitcnt vmcnt(2)
    v_mfma_f32_16x16x32_bf16 v[20:23], v[196:199], v[64:67], v[20:23]
    v_and_b32 v3, 3, v2
    v_lshl_add_u32 v3, v3, 1, s35
    v_add_u32_e64 v7, v7, v3
    v_mfma_f32_16x16x32_bf16 v[24:27], v[200:203], v[64:67], v[24:27]
    v_mfma_f32_16x16x32_bf16 v[28:31], v[204:207], v[64:67], v[28:31]
    v_mfma_f32_16x16x32_bf16 v[32:35], v[208:211], v[64:67], v[32:35]
    v_mfma_f32_16x16x32_bf16 v[36:39], v[212:215], v[64:67], v[36:39]
    s_waitcnt vmcnt(1)
    v_mfma_f32_16x16x32_bf16 v[20:23], v[216:219], v[68:71], v[20:23]
    v_mfma_f32_16x16x32_bf16 v[24:27], v[220:223], v[68:71], v[24:27]
    v_mfma_f32_16x16x32_bf16 v[28:31], v[224:227], v[68:71], v[28:31]
    v_mfma_f32_16x16x32_bf16 v[32:35], v[228:231], v[68:71], v[32:35]
    v_mfma_f32_16x16x32_bf16 v[36:39], v[232:235], v[68:71], v[36:39]
    s_waitcnt vmcnt(0)
    v_mfma_f32_16x16x32_bf16 v[20:23], v[236:239], v[72:75], v[20:23]
    v_mfma_f32_16x16x32_bf16 v[24:27], v[240:243], v[72:75], v[24:27]
    v_mfma_f32_16x16x32_bf16 v[28:31], v[244:247], v[72:75], v[28:31]
    v_mfma_f32_16x16x32_bf16 v[32:35], v[248:251], v[72:75], v[32:35]
    ds_write_b128 v15, v[20:23] offset:0
    v_mfma_f32_16x16x32_bf16 v[36:39], v[252:255], v[72:75], v[36:39]
    ds_write_b128 v15, v[24:27] offset:1024
    s_nop 5
    ds_write_b128 v15, v[28:31] offset:2048
    ds_write_b128 v15, v[32:35] offset:3072
    ds_write_b128 v15, v[36:39] offset:4096
    s_waitcnt lgkmcnt(0)
    s_barrier
    ds_read_u16 v48, v6 offset:9216
    ds_read2st64_b32 v[40:41], v5 offset0:0 offset1:20
    ds_read2st64_b32 v[42:43], v5 offset0:40 offset1:60
    ds_read2st64_b32 v[44:45], v5 offset0:80 offset1:100
    ds_read2st64_b32 v[46:47], v5 offset0:120 offset1:140
    s_waitcnt lgkmcnt(2)
    v_lshlrev_b32_e64 v48, 16, v48
    v_pk_add_f32 v[40:41], v[40:41], v[42:43]
    s_waitcnt lgkmcnt(0)
    v_pk_add_f32 v[44:45], v[44:45], v[46:47]
    v_add_f32 v40, v40, v48
    v_pk_add_f32 v[40:41], v[40:41], v[44:45]
    v_add_f32_e64 v40, v40, v41
    v_cvt_pk_bf16_f32 v40, v40, v40
    buffer_store_short v40, v7, s[52:55], s79 offen
    s_waitcnt vmcnt(0)
    s_endpgm
L_idleh3:
    s_cmp_lg_u32 s30, 7
    s_cbranch_scc1 L_o7125
    v_mov_b32 v3, 16384
    v_mov_b32 v16, 0
    v_mov_b32 v17, 0
    v_mov_b32 v18, 0
    v_mov_b32 v19, 0
    ds_write_b128 v3, v[16:19]
    s_waitcnt lgkmcnt(0)
L_o7125:
    s_waitcnt lgkmcnt(0)
    s_barrier
    s_add_u32 s35, s36, 0
    buffer_load_dwordx4 v[76:79], v10, s[44:47], s35 offen offset:0 sc1
    buffer_load_dwordx4 v[80:83], v10, s[44:47], s35 offen offset:1024 sc1
    buffer_load_dwordx4 v[84:87], v10, s[44:47], s35 offen offset:2048 sc1
    buffer_load_dwordx4 v[88:91], v10, s[44:47], s35 offen offset:3072 sc1
    s_add_u32 s35, s36, 4096
    buffer_load_dwordx4 v[92:95], v10, s[44:47], s35 offen offset:0 sc1
    buffer_load_dwordx4 v[96:99], v10, s[44:47], s35 offen offset:1024 sc1
    buffer_load_dwordx4 v[100:103], v10, s[44:47], s35 offen offset:2048 sc1
    buffer_load_dwordx4 v[104:107], v10, s[44:47], s35 offen offset:3072 sc1
    s_add_u32 s35, s36, 8192
    buffer_load_dwordx4 v[108:111], v10, s[44:47], s35 offen offset:0 sc1
    buffer_load_dwordx4 v[112:115], v10, s[44:47], s35 offen offset:1024 sc1
    buffer_load_dwordx4 v[116:119], v10, s[44:47], s35 offen offset:2048 sc1
    buffer_load_dwordx4 v[120:123], v10, s[44:47], s35 offen offset:3072 sc1
    s_add_u32 s35, s36, 12288
    buffer_load_dwordx4 v[124:127], v10, s[44:47], s35 offen offset:0 sc1
    buffer_load_dwordx4 v[128:131], v10, s[44:47], s35 offen offset:1024 sc1
    buffer_load_dwordx4 v[132:135], v10, s[44:47], s35 offen offset:2048 sc1
    buffer_load_dwordx4 v[136:139], v10, s[44:47], s35 offen offset:3072 sc1
    s_add_u32 s35, s36, 16384
    buffer_load_dwordx4 v[140:143], v10, s[44:47], s35 offen offset:0 sc1
    buffer_load_dwordx4 v[144:147], v10, s[44:47], s35 offen offset:1024 sc1
    buffer_load_dwordx4 v[148:151], v10, s[44:47], s35 offen offset:2048 sc1
    buffer_load_dwordx4 v[152:155], v10, s[44:47], s35 offen offset:3072 sc1
    s_add_u32 s35, s36, 20480
    buffer_load_dwordx4 v[156:159], v10, s[44:47], s35 offen offset:0 sc1
    buffer_load_dwordx4 v[160:163], v10, s[44:47], s35 offen offset:1024 sc1
    buffer_load_dwordx4 v[164:167], v10, s[44:47], s35 offen offset:2048 sc1
    buffer_load_dwordx4 v[168:171], v10, s[44:47], s35 offen offset:3072 sc1
    s_add_u32 s35, s36, 24576
    buffer_load_dwordx4 v[172:175], v10, s[44:47], s35 offen offset:0 sc1
    buffer_load_dwordx4 v[176:179], v10, s[44:47], s35 offen offset:1024 sc1
    buffer_load_dwordx4 v[180:183], v10, s[44:47], s35 offen offset:2048 sc1
    buffer_load_dwordx4 v[184:187], v10, s[44:47], s35 offen offset:3072 sc1
    s_add_u32 s35, s36, 28672
    buffer_load_dwordx4 v[188:191], v10, s[44:47], s35 offen offset:0 sc1
    buffer_load_dwordx4 v[192:195], v10, s[44:47], s35 offen offset:1024 sc1
    buffer_load_dwordx4 v[196:199], v10, s[44:47], s35 offen offset:2048 sc1
    buffer_load_dwordx4 v[200:203], v10, s[44:47], s35 offen offset:3072 sc1
    s_add_u32 s35, s36, 32768
    buffer_load_dwordx4 v[204:207], v10, s[44:47], s35 offen offset:0 sc1
    buffer_load_dwordx4 v[208:211], v10, s[44:47], s35 offen offset:1024 sc1
    buffer_load_dwordx4 v[212:215], v10, s[44:47], s35 offen offset:2048 sc1
    buffer_load_dwordx4 v[216:219], v10, s[44:47], s35 offen offset:3072 sc1
    s_add_u32 s35, s36, 36864
    buffer_load_dwordx4 v[220:223], v10, s[44:47], s35 offen offset:0 sc1
    buffer_load_dwordx4 v[224:227], v10, s[44:47], s35 offen offset:1024 sc1
    buffer_load_dwordx4 v[228:231], v10, s[44:47], s35 offen offset:2048 sc1
    buffer_load_dwordx4 v[232:235], v10, s[44:47], s35 offen offset:3072 sc1
    s_add_u32 s35, s36, 40960
    buffer_load_dwordx4 v[236:239], v10, s[44:47], s35 offen offset:0 sc1
    buffer_load_dwordx4 v[240:243], v10, s[44:47], s35 offen offset:1024 sc1
    buffer_load_dwordx4 v[244:247], v10, s[44:47], s35 offen offset:2048 sc1
    buffer_load_dwordx4 v[248:251], v10, s[44:47], s35 offen offset:3072 sc1
    s_add_u32 s35, s36, 45056
    buffer_load_dwordx4 v[252:255], v10, s[44:47], s35 offen offset:0 sc1
    s_add_u32 m0, s37, 86016
    s_add_u32 s35, s37, s39
    s_add_u32 s35, s35, 184320
    buffer_load_dwordx4 v10, s[44:47], s35 offen offset:0 sc1 lds
    buffer_load_dwordx4 v10, s[44:47], s35 offen offset:1024 sc1 lds
    buffer_load_dwordx4 v10, s[44:47], s35 offen offset:2048 sc1 lds
    buffer_load_dwordx4 v10, s[44:47], s35 offen offset:3072 sc1 lds
    s_add_u32 m0, s37, 90112
    s_add_u32 s35, s37, s39
    s_add_u32 s35, s35, 188416
    buffer_load_dwordx4 v10, s[44:47], s35 offen offset:0 sc1 lds
    buffer_load_dwordx4 v10, s[44:47], s35 offen offset:1024 sc1 lds
    buffer_load_dwordx4 v10, s[44:47], s35 offen offset:2048 sc1 lds
    buffer_load_dwordx4 v10, s[44:47], s35 offen offset:3072 sc1 lds
    s_add_u32 m0, s37, 94208
    s_add_u32 s35, s37, s39
    s_add_u32 s35, s35, 192512
    buffer_load_dwordx4 v10, s[44:47], s35 offen offset:0 sc1 lds
    buffer_load_dwordx4 v10, s[44:47], s35 offen offset:1024 sc1 lds
    buffer_load_dwordx4 v10, s[44:47], s35 offen offset:2048 sc1 lds
    buffer_load_dwordx4 v10, s[44:47], s35 offen offset:3072 sc1 lds
    s_add_u32 m0, s37, 98304
    s_add_u32 s35, s37, s39
    s_add_u32 s35, s35, 196608
    buffer_load_dwordx4 v10, s[44:47], s35 offen offset:0 sc1 lds
    buffer_load_dwordx4 v10, s[44:47], s35 offen offset:1024 sc1 lds
    buffer_load_dwordx4 v10, s[44:47], s35 offen offset:2048 sc1 lds
    buffer_load_dwordx4 v10, s[44:47], s35 offen offset:3072 sc1 lds
    s_add_u32 m0, s37, 102400
    s_add_u32 s35, s37, s39
    s_add_u32 s35, s35, 200704
    buffer_load_dwordx4 v10, s[44:47], s35 offen offset:0 sc1 lds
    buffer_load_dwordx4 v10, s[44:47], s35 offen offset:1024 sc1 lds
    buffer_load_dwordx4 v10, s[44:47], s35 offen offset:2048 sc1 lds
    s_lshl_b32 s35, s29, 12
    s_add_u32 m0, s35, 0
    s_add_u32 s35, s35, s39
    s_add_u32 s35, s35, 261120
    buffer_load_dwordx4 v10, s[44:47], s35 offen offset:0 sc1 lds
    buffer_load_dwordx4 v10, s[44:47], s35 offen offset:1024 sc1 lds
    buffer_load_dwordx4 v10, s[44:47], s35 offen offset:2048 sc1 lds
    buffer_load_dwordx4 v10, s[44:47], s35 offen offset:3072 sc1 lds
    v_mov_b32 v58, 83980
    s_mov_b32 s87, 0
L_sp126:
    ds_read_b32 v59, v58
    s_add_u32 s87, s87, 1
    s_waitcnt lgkmcnt(0)
    v_readfirstlane_b32 s86, v59
    s_cmp_ge_u32 s86, 1
    s_cbranch_scc1 L_sd127
    s_sleep 4
    s_cmp_lt_u32 s87, 200000
    s_cbranch_scc1 L_sp126
L_sd127:
    s_mov_b32 s35, s76
    s_cmp_eq_u32 s29, 1
    s_cselect_b32 s35, s77, s35
    s_cmp_eq_u32 s29, 2
    s_cselect_b32 s35, s78, s35
    s_cmp_eq_u32 s29, 3
    s_cselect_b32 s35, s79, s35
    s_mul_i32 s38, s67, 4960
    s_add_u32 s35, s35, s38
    s_and_b32 s38, s59, 1
    s_mul_i32 s38, s38, 2528
    s_sub_u32 s35, s35, s38
    s_mul_i32 s38, s29, 3072
    s_add_u32 m0, s38, 20480
    s_nop 0
    buffer_load_dwordx4 v13, s[20:23], s35 offen sc1 lds
    s_add_u32 s35, s35, 2048
    s_add_u32 m0, s38, 21504
    s_nop 0
    buffer_load_dwordx4 v13, s[20:23], s35 offen sc1 lds
    s_add_u32 s35, s35, 2048
    s_add_u32 m0, s38, 22528
    s_nop 0
    buffer_load_dwordx4 v13, s[20:23], s35 offen sc1 lds
    buffer_load_dwordx4 v[20:23], v12, s[48:51], s4 offen sc1
    buffer_load_dwordx4 v[24:27], v12, s[48:51], s5 offen sc1
    s_waitcnt vmcnt(0)
    s_cmp_lg_u32 s30, 7
    s_cbranch_scc1 L_o7128
    s_mov_b32 s87, 0
L_pl129:
    v_xor_b32 v20, s56, v20
    v_xor_b32 v21, s56, v21
    v_xor_b32 v22, s56, v22
    v_xor_b32_e64 v23, s56, v23
    v_or3_b32 v20, v20, v21, v22
    v_or_b32_e64 v20, v20, v23
    v_cmp_ne_u32 vcc, 0, v20
    s_add_u32 s87, s87, 1
    s_cbranch_vccz L_pd130
    s_sleep 24
    buffer_load_dwordx4 v[20:23], v12, s[48:51], s4 offen sc1
    s_cmp_lt_u32 s87, 20000
    s_waitcnt vmcnt(0)
    s_cbranch_scc1 L_pl129
L_pd130:
    s_mov_b32 s87, 0
L_pl131:
    v_xor_b32 v24, s56, v24
    v_xor_b32 v25, s56, v25
    v_xor_b32 v26, s56, v26
    v_xor_b32_e64 v27, s56, v27
    v_or3_b32 v24, v24, v25, v26
    v_or_b32_e64 v24, v24, v27
    v_cmp_ne_u32 vcc, 0, v24
    s_add_u32 s87, s87, 1
    s_cbranch_vccz L_pd132
    s_sleep 24
    buffer_load_dwordx4 v[24:27], v12, s[48:51], s5 offen sc1
    s_cmp_lt_u32 s87, 20000
    s_waitcnt vmcnt(0)
    s_cbranch_scc1 L_pl131
L_pd132:
L_o7128:
    s_barrier
    s_add_u32 s80, s72, s83
    s_add_u32 s81, s80, 4096
    s_add_u32 s82, s80, 8192
    buffer_load_dwordx4 v[40:43], v10, s[40:43], s80 offen offset:0 sc1
    buffer_load_dwordx4 v[44:47], v10, s[40:43], s80 offen offset:1024 sc1
    buffer_load_dwordx4 v[48:51], v10, s[40:43], s80 offen offset:2048 sc1
    buffer_load_dwordx4 v[52:55], v10, s[40:43], s80 offen offset:3072 sc1
    buffer_load_dwordx4 v[56:59], v10, s[40:43], s81 offen offset:0 sc1
    buffer_load_dwordx4 v[60:63], v10, s[40:43], s81 offen offset:1024 sc1
    buffer_load_dwordx4 v[64:67], v10, s[40:43], s81 offen offset:2048 sc1
    buffer_load_dwordx4 v[68:71], v10, s[40:43], s81 offen offset:3072 sc1
    buffer_load_dwordx4 v[72:75], v10, s[40:43], s82 offen offset:0 sc1
    s_branch L_g2h5
L_end1:
    s_endpgm

.section .rodata,"a"
.p2align 6
.amdhsa_kernel sequential_preLN__ssm_conv_s4d__glu_gated_swiglu__prompt_kernel
  .amdhsa_next_free_vgpr 256
  .amdhsa_next_free_sgpr 102
  .amdhsa_accum_offset 256
  .amdhsa_group_segment_fixed_size 0
  .amdhsa_kernarg_size 112
  .amdhsa_user_sgpr_count 2
  .amdhsa_user_sgpr_kernarg_segment_ptr 1
  .amdhsa_system_sgpr_workgroup_id_x 1
.end_amdhsa_kernel
```
